```python
import torch

def _softmax(x, axis=-1):
    return torch.softmax(x, dim=axis)
def _gelu(x):
    return torch.nn.functional.gelu(x, approximate="tanh")
def _silu(x):
    return torch.nn.functional.silu(x)
def _sigmoid(x):
    return torch.sigmoid(x)
def _layernorm(x, axis=-1, eps=1e-5):
    m = x.mean(dim=axis, keepdim=True)
    v = x.var(dim=axis, keepdim=True, unbiased=False)
    return (x - m) / torch.sqrt(v + eps)
def _scatter_add(tgt, idx, src, axis=0):
    return tgt.clone().index_add_(axis, idx, src)
def _segment_sum(src, seg, n):
    out = torch.zeros((n,) + src.shape[1:], dtype=src.dtype)
    return out.index_add_(0, seg, src)
def _pad(x, pw):
    flat = tuple(v for pair in reversed(pw) for v in pair)
    return torch.nn.functional.pad(x, flat)

kernel_name = 'standalone__fused_io_aware_attn__prompt'

def setup_inputs():

    _w = (lambda a: (lambda t: t.to(torch.bfloat16) if t.is_floating_point() else t)(torch.as_tensor(a)))
    B, H, S = 2, 16, 2048
    Dh = max(1, 448 // 16)
    return {
        "q": _w((lambda *s: torch.randn(*s, dtype=torch.bfloat16) * 0.8)(B, H, S, Dh)),
        "k": _w((lambda *s: torch.randn(*s, dtype=torch.bfloat16) * 0.8)(B, H, S, Dh)),
        "v": _w((lambda *s: torch.randn(*s, dtype=torch.bfloat16) * 0.05)(B, H, S, Dh)),
    }

def reference(q, k, v):
    scale = q.shape[-1] ** -0.5
    s = torch.einsum('bhqd,bhkd->bhqk', q, k) * scale
    p = _softmax(s, axis=-1)
    return torch.einsum('bhqk,bhkd->bhqd', p, v)
```

```asm
; @launch grid=(256,1,1) block=(512,1,1) lds=151552
.amdgcn_target "amdgcn-amd-amdhsa--gfx950"
.text
.globl standalone__fused_io_aware_attn__prompt_kernel
.p2align 8
.type standalone__fused_io_aware_attn__prompt_kernel,@function
standalone__fused_io_aware_attn__prompt_kernel:
    s_load_dwordx8 s[4:11], s[0:1], 0x0
    s_cmp_ge_u32 s2, 0x100
    s_cbranch_scc1 L_end
    s_setprio 3
    s_getpc_b64 s[50:51]
L_pc:
    s_lshr_b32 s52, s2, 3
    s_lshl_b32 s52, s52, 9
    v_and_b32 v239, 0x1c0, v0
    v_add_u32 v239, s52, v239
    v_min_u32 v239, L_end-L_pc, v239
    global_load_dword v239, v239, s[50:51]
    v_lshrrev_b32 v1, 6, v0
    v_and_b32 v2, 63, v0
    v_readfirstlane_b32 s28, v1
    s_and_b32 s3, s2, 7
    s_lshr_b32 s29, s2, 6
    s_lshl_b32 s29, s29, 3
    s_add_u32 s3, s3, s29
    s_mul_i32 s29, s3, 114688
    s_bfe_u32 s33, s2, 0x30003
    s_mul_i32 s33, s33, 14336
    s_add_u32 s33, s33, s29
    v_and_b32 v224, 31, v2
    v_lshrrev_b32 v225, 5, v2
    v_mul_u32_u24 v224, 56, v224
    v_mad_u32_u24 v5, v225, 24, v224
    v_lshlrev_b32 v4, 4, v2
    s_mul_i32 s38, s28, 1792
    s_lshr_b32 s36, s28, 2
    s_and_b32 s39, s28, 1
    s_lshl_b32 s34, s36, 1
    s_add_u32 s34, s34, s39
    s_lshl_b32 s34, s34, 11
    s_min_u32 s34, s34, 5120
    s_mov_b32 s14, 14336
    s_mov_b32 s15, 0x20000
    s_mov_b32 s18, 114688
    s_mov_b32 s19, 0x20000
    s_bitcmp1_b32 s28, 1
    s_cselect_b32 s31, 57344, 0
    s_add_u32 s31, s31, s34
    s_mov_b32 m0, s31
    v_mov_b32 v226, 0x3f80
    v_mov_b32 v227, 0
    v_lshlrev_b32 v228, 3, v0
    v_add_u32 v228, 114688, v228
    s_waitcnt lgkmcnt(0)
    s_bitcmp1_b32 s28, 1
    s_cselect_b32 s16, s8, s6
    s_cselect_b32 s17, s9, s7
    s_add_u32 s16, s16, s29
    s_addc_u32 s17, s17, 0
    buffer_load_dwordx4 v4, s[16:19], s34 offen lds
    buffer_load_dwordx4 v4, s[16:19], s34 offen offset:1024 lds
    s_setprio 2
    s_add_u32 s12, s4, s33
    s_addc_u32 s13, s5, 0
    buffer_load_dwordx4 v[216:219], v5, s[12:15], s38 offen offset:0
    buffer_load_dwordx4 v[220:223], v5, s[12:15], s38 offen offset:16
    s_setprio 1
    s_add_u32 m0, s31, 7168
    s_add_u32 s30, s34, 7168
    buffer_load_dwordx4 v4, s[16:19], s30 offen offset:0 lds
    buffer_load_dwordx4 v4, s[16:19], s30 offen offset:1024 lds
    s_setprio 0
    ds_write_b64 v228, v[226:227] offset:0
    s_add_u32 s20, s10, s33
    s_addc_u32 s21, s11, 0
    s_mov_b32 s22, 14336
    s_mov_b32 s23, 0x20000
    s_mov_b32 s44, 0x5f800000
    s_mov_b64 s[46:47], 0
    v_mov_b32 v234, 0x3e8b97f6
    v_mov_b32 v235, 0x3e8b97f6
    v_cmp_eq_u32 vcc, 0, v225
    v_mov_b32 v238, 0xffff0000
    v_mov_b32 v96, 0
    v_mov_b32 v97, 0
    v_mov_b32 v98, 0
    v_mov_b32 v99, 0
    v_cndmask_b32 v236, 0, v234, vcc
    v_cndmask_b32 v237, 0, v234, vcc
    v_mfma_f32_32x32x16_bf16 v[176:191], v[96:99], v[96:99], 0
    v_mfma_f32_32x32x16_bf16 v[128:143], v[96:99], v[96:99], 0
    s_and_b32 s35, s28, 3
    s_mul_i32 s41, s35, 1792
    v_add_u32 v3, s41, v5
    s_lshl_b32 s48, s28, 12
    v_lshl_add_u32 v14, v225, 5, v224
    v_add_u32 v14, s48, v14
    v_add_u32 v242, s48, v4
    v_add_u32 v244, 118784, v242
    s_and_b32 s37, s28, 4
    s_add_u32 s40, s28, 1
    s_and_b32 s40, s40, 3
    s_or_b32 s40, s40, s37
    s_lshl_b32 s40, s40, 12
    s_add_u32 s53, s28, 2
    s_and_b32 s53, s53, 3
    s_or_b32 s53, s53, s37
    s_lshl_b32 s53, s53, 12
    s_add_u32 s54, s28, 3
    s_and_b32 s54, s54, 3
    s_or_b32 s54, s54, s37
    s_lshl_b32 s54, s54, 12
    v_add_u32 v233, 118784, v4
    v_add_u32 v0, s40, v233
    v_add_u32 v1, s53, v233
    v_add_u32 v243, s54, v233
    v_mfma_f32_32x32x16_bf16 v[144:159], v[96:99], v[96:99], 0
    v_mfma_f32_32x32x16_bf16 v[160:175], v[96:99], v[96:99], 0
    v_bfe_u32 v229, v2, 2, 2
    v_lshl_add_u32 v229, v225, 3, v229
    v_mul_u32_u24 v229, 56, v229
    v_and_b32 v230, 16, v2
    v_add_u32 v229, v229, v230
    v_and_b32 v230, 2, v2
    v_lshl_add_u32 v229, v230, 2, v229
    v_and_b32 v230, 1, v2
    v_lshl_add_u32 v229, v230, 5, v229
    v_and_b32 v230, 0x13, v2
    v_cmp_eq_u32 vcc, 0x13, v230
    v_lshlrev_b32 v231, 6, v225
    v_sub_u32 v231, 114912, v231
    v_add_u32 v240, 57344, v229
    v_add_u32 v241, 3584, v240
    v_add_u32 v6, s41, v240
    v_mov_b32 v232, 7168
    v_cndmask_b32 v240, v240, v231, vcc
    v_cndmask_b32 v241, v241, v231, vcc
    v_cndmask_b32 v6, v6, v231, vcc
    v_cndmask_b32 v232, v232, 0, vcc
    v_add_u32 v7, v6, v232
    v_add_u32 v8, v7, v232
    v_add_u32 v9, v8, v232
    v_add_u32 v10, v9, v232
    v_add_u32 v11, v10, v232
    v_add_u32 v12, v11, v232
    v_add_u32 v13, v12, v232
    v_mov_b32 v15, 0xdddddddd
    s_waitcnt vmcnt(4) lgkmcnt(0)
    s_barrier
    s_setprio 3
    ds_read_b64 v[40:41], v5 offset:0
    ds_read_b64 v[42:43], v5 offset:8
    ds_read_b64 v[44:45], v5 offset:16
    ds_read_b64 v[46:47], v5 offset:24
    ds_read_b64 v[48:49], v5 offset:1792
    ds_read_b64 v[50:51], v5 offset:1800
    ds_read_b64 v[52:53], v5 offset:1808
    ds_read_b64 v[54:55], v5 offset:1816
    ds_read_b64_tr_b16 v[16:17], v240 offset:0
    ds_read_b64_tr_b16 v[18:19], v240 offset:224
    ds_read_b64_tr_b16 v[20:21], v240 offset:896
    ds_read_b64_tr_b16 v[22:23], v240 offset:1120
    s_waitcnt vmcnt(3)
    v_lshlrev_b32 v112, 16, v216
    v_and_b32 v113, v238, v216
    v_pk_mul_f32 v[112:113], v[112:113], v[236:237]
    v_cvt_pk_bf16_f32 v216, v112, v113
    v_lshlrev_b32 v114, 16, v217
    v_and_b32 v115, v238, v217
    v_pk_mul_f32 v[114:115], v[114:115], v[236:237]
    v_cvt_pk_bf16_f32 v217, v114, v115
    v_lshlrev_b32 v116, 16, v218
    v_and_b32 v117, v238, v218
    v_pk_mul_f32 v[116:117], v[116:117], v[234:235]
    v_cvt_pk_bf16_f32 v218, v116, v117
    v_lshlrev_b32 v118, 16, v219
    v_and_b32 v119, v238, v219
    v_pk_mul_f32 v[118:119], v[118:119], v[234:235]
    v_cvt_pk_bf16_f32 v219, v118, v119
    s_waitcnt vmcnt(2)
    v_lshlrev_b32 v120, 16, v220
    v_and_b32 v121, v238, v220
    v_pk_mul_f32 v[120:121], v[120:121], v[234:235]
    v_cvt_pk_bf16_f32 v220, v120, v121
    s_waitcnt lgkmcnt(10)
    v_mfma_f32_32x32x16_bf16 v[64:79], v[40:43], v[216:219], 0
    v_lshlrev_b32 v122, 16, v221
    v_and_b32 v123, v238, v221
    v_pk_mul_f32 v[122:123], v[122:123], v[234:235]
    v_cvt_pk_bf16_f32 v221, v122, v123
    v_lshlrev_b32 v124, 16, v222
    v_and_b32 v125, v238, v222
    v_pk_mul_f32 v[124:125], v[124:125], v[234:235]
    v_cvt_pk_bf16_f32 v222, v124, v125
    v_lshlrev_b32 v126, 16, v223
    v_and_b32 v127, v238, v223
    v_pk_mul_f32 v[126:127], v[126:127], v[234:235]
    v_cvt_pk_bf16_f32 v223, v126, v127
    ds_write_b128 v244, v[216:219] offset:0
    s_nop 0
    s_waitcnt lgkmcnt(9)
    v_mfma_f32_32x32x16_bf16 v[64:79], v[44:47], v[220:223], v[64:79]
    ds_read_b64 v[40:41], v5 offset:3584
    ds_read_b64 v[42:43], v5 offset:3592
    ds_read_b64 v[44:45], v5 offset:3600
    ds_read_b64 v[46:47], v5 offset:3608
    s_waitcnt lgkmcnt(11)
    v_mfma_f32_32x32x16_bf16 v[80:95], v[48:51], v[216:219], 0
    ds_write_b128 v244, v[220:223] offset:1024
    s_nop 5
    v_exp_f32 v64, v64
    v_exp_f32 v65, v65
    s_waitcnt lgkmcnt(10)
    v_mfma_f32_32x32x16_bf16 v[80:95], v[52:55], v[220:223], v[80:95]
    s_waitcnt lgkmcnt(1)
    s_setprio 2
    s_add_u32 m0, s31, 14336
    s_add_u32 s30, s34, 14336
    buffer_load_dwordx4 v4, s[16:19], s30 offen offset:0 lds
    ds_read_b64 v[48:49], v5 offset:5376
    ds_read_b64 v[50:51], v5 offset:5384
    v_exp_f32 v66, v66
    v_exp_f32 v67, v67
    v_exp_f32 v68, v68
    v_exp_f32 v69, v69
    v_mfma_f32_32x32x16_bf16 v[96:111], v[40:43], v[216:219], 0
    ds_read_b64 v[52:53], v5 offset:5392
    ds_read_b64 v[54:55], v5 offset:5400
    ds_read_b64_tr_b16 v[24:25], v240 offset:1792
    ds_read_b64_tr_b16 v[26:27], v240 offset:2016
    v_exp_f32 v70, v70
    v_exp_f32 v71, v71
    v_exp_f32 v72, v72
    v_exp_f32 v73, v73
    v_mfma_f32_32x32x16_bf16 v[96:111], v[44:47], v[220:223], v[96:111]
    s_setprio 1
    buffer_load_dwordx4 v4, s[16:19], s30 offen offset:1024 lds
    ds_read_b64_tr_b16 v[28:29], v240 offset:2688
    ds_read_b64_tr_b16 v[30:31], v240 offset:2912
    v_exp_f32 v74, v74
    v_exp_f32 v75, v75
    v_exp_f32 v76, v76
    v_exp_f32 v77, v77
    v_smfmac_f32_32x32x32_bf16 v[176:191], v[16:19], v[64:71], v15
    s_waitcnt lgkmcnt(4)
    v_exp_f32 v78, v78
    v_exp_f32 v79, v79
    v_mfma_f32_32x32x16_bf16 v[112:127], v[48:51], v[216:219], 0
    s_setprio 0
    s_add_u32 m0, s31, 21504
    s_add_u32 s30, s34, 21504
    buffer_load_dwordx4 v4, s[16:19], s30 offen offset:0 lds
    ds_read_b64_tr_b16 v[16:17], v241 offset:0
    ds_read_b64_tr_b16 v[18:19], v241 offset:224
    v_exp_f32 v80, v80
    v_exp_f32 v81, v81
    v_exp_f32 v82, v82
    v_exp_f32 v83, v83
    v_mfma_f32_32x32x16_bf16 v[112:127], v[52:55], v[220:223], v[112:127]
    v_exp_f32 v84, v84
    v_exp_f32 v85, v85
    v_exp_f32 v86, v86
    v_exp_f32 v87, v87
    v_smfmac_f32_32x32x32_bf16 v[176:191], v[20:23], v[72:79], v15
    s_waitcnt lgkmcnt(4)
    buffer_load_dwordx4 v4, s[16:19], s30 offen offset:1024 lds
    ds_read_b64_tr_b16 v[20:21], v241 offset:896
    ds_read_b64_tr_b16 v[22:23], v241 offset:1120
    v_exp_f32 v88, v88
    v_exp_f32 v89, v89
    v_exp_f32 v90, v90
    v_exp_f32 v91, v91
    v_smfmac_f32_32x32x32_bf16 v[176:191], v[24:27], v[80:87], v15
    s_waitcnt vmcnt(4)
    s_barrier
    s_setprio 3
    ds_read_b64 v[40:41], v3 offset:7168
    ds_read_b64 v[42:43], v3 offset:7176
    ds_read_b128 v[192:195], v0 offset:0
    ds_read_b64 v[44:45], v3 offset:7184
    ds_read_b64 v[46:47], v3 offset:7192
    ds_read_b128 v[196:199], v0 offset:1024
    ds_read_b128 v[200:203], v1 offset:0
    ds_read_b128 v[204:207], v1 offset:1024
    v_exp_f32 v92, v92
    v_exp_f32 v93, v93
    v_exp_f32 v94, v94
    v_exp_f32 v95, v95
    v_exp_f32 v96, v96
    v_exp_f32 v97, v97
    s_waitcnt lgkmcnt(12)
    v_smfmac_f32_32x32x32_bf16 v[176:191], v[28:31], v[88:95], v15
    s_add_u32 m0, s31, 28672
    s_add_u32 s30, s34, 28672
    buffer_load_dwordx4 v4, s[16:19], s30 offen offset:0 lds
    ds_read_b64_tr_b16 v[24:25], v241 offset:1792
    ds_read_b64_tr_b16 v[26:27], v241 offset:2016
    v_exp_f32 v98, v98
    v_exp_f32 v99, v99
    v_exp_f32 v100, v100
    v_exp_f32 v101, v101
    s_waitcnt lgkmcnt(4)
    v_mfma_f32_32x32x16_bf16 v[64:79], v[40:43], v[192:195], 0
    ds_read_b64_tr_b16 v[28:29], v241 offset:2688
    ds_read_b64_tr_b16 v[30:31], v241 offset:2912
    v_exp_f32 v102, v102
    v_exp_f32 v103, v103
    v_exp_f32 v104, v104
    v_exp_f32 v105, v105
    v_mfma_f32_32x32x16_bf16 v[64:79], v[44:47], v[196:199], v[64:79]
    buffer_load_dwordx4 v4, s[16:19], s30 offen offset:1024 lds
    ds_read_b128 v[208:211], v243 offset:0
    ds_read_b128 v[212:215], v243 offset:1024
    v_exp_f32 v106, v106
    v_exp_f32 v107, v107
    v_exp_f32 v108, v108
    v_smfmac_f32_32x32x32_bf16 v[176:191], v[16:19], v[96:103], v15
    s_waitcnt lgkmcnt(6)
    v_exp_f32 v109, v109
    v_exp_f32 v110, v110
    v_exp_f32 v111, v111
    v_mfma_f32_32x32x16_bf16 v[80:95], v[40:43], v[200:203], 0
    s_add_u32 m0, s31, 35840
    s_add_u32 s30, s34, 35840
    buffer_load_dwordx4 v4, s[16:19], s30 offen offset:0 lds
    ds_read_b64_tr_b16 v[16:17], v7 offset:0
    v_exp_f32 v112, v112
    v_exp_f32 v113, v113
    v_exp_f32 v114, v114
    v_exp_f32 v115, v115
    v_mfma_f32_32x32x16_bf16 v[80:95], v[44:47], v[204:207], v[80:95]
    s_setprio 2
    ds_read_b64_tr_b16 v[18:19], v7 offset:224
    v_exp_f32 v116, v116
    v_exp_f32 v117, v117
    v_exp_f32 v118, v118
    v_exp_f32 v119, v119
    v_smfmac_f32_32x32x32_bf16 v[176:191], v[20:23], v[104:111], v15
    s_waitcnt lgkmcnt(6)
    s_setprio 1
    buffer_load_dwordx4 v4, s[16:19], s30 offen offset:1024 lds
    ds_read_b64_tr_b16 v[20:21], v7 offset:896
    v_exp_f32 v120, v120
    v_exp_f32 v121, v121
    v_exp_f32 v122, v122
    v_exp_f32 v123, v123
    v_smfmac_f32_32x32x32_bf16 v[176:191], v[24:27], v[112:119], v15
    s_waitcnt lgkmcnt(3)
    ds_read_b64_tr_b16 v[22:23], v7 offset:1120
    s_waitcnt vmcnt(4)
    s_barrier
    s_setprio 3
    v_exp_f32 v124, v124
    v_exp_f32 v125, v125
    v_exp_f32 v126, v126
    v_exp_f32 v127, v127
    v_mfma_f32_32x32x16_bf16 v[96:111], v[40:43], v[208:211], 0
    ds_read_b64 v[48:49], v3 offset:14336
    v_exp_f32 v64, v64
    v_exp_f32 v65, v65
    v_exp_f32 v66, v66
    v_exp_f32 v67, v67
    v_mfma_f32_32x32x16_bf16 v[96:111], v[44:47], v[212:215], v[96:111]
    ds_read_b64 v[50:51], v3 offset:14344
    v_exp_f32 v68, v68
    v_exp_f32 v69, v69
    v_exp_f32 v70, v70
    v_exp_f32 v71, v71
    v_smfmac_f32_32x32x32_bf16 v[176:191], v[28:31], v[120:127], v15
    s_waitcnt lgkmcnt(4)
    ds_read_b64 v[52:53], v3 offset:14352
    v_exp_f32 v72, v72
    v_exp_f32 v73, v73
    v_exp_f32 v74, v74
    v_exp_f32 v75, v75
    v_smfmac_f32_32x32x32_bf16 v[128:143], v[16:19], v[64:71], v15
    ds_read_b64 v[54:55], v3 offset:14360
    v_exp_f32 v76, v76
    v_exp_f32 v77, v77
    v_exp_f32 v78, v78
    v_exp_f32 v79, v79
    v_mfma_f32_32x32x16_bf16 v[112:127], v[40:43], v[216:219], 0
    s_add_u32 m0, s31, 43008
    s_add_u32 s30, s34, 43008
    buffer_load_dwordx4 v4, s[16:19], s30 offen offset:0 lds
    v_exp_f32 v80, v80
    v_exp_f32 v81, v81
    v_exp_f32 v82, v82
    v_exp_f32 v83, v83
    v_mfma_f32_32x32x16_bf16 v[112:127], v[44:47], v[220:223], v[112:127]
    s_waitcnt lgkmcnt(4)
    v_exp_f32 v84, v84
    v_exp_f32 v85, v85
    v_exp_f32 v86, v86
    v_exp_f32 v87, v87
    v_smfmac_f32_32x32x32_bf16 v[128:143], v[20:23], v[72:79], v15
    buffer_load_dwordx4 v4, s[16:19], s30 offen offset:1024 lds
    v_exp_f32 v88, v88
    v_exp_f32 v89, v89
    v_exp_f32 v90, v90
    v_exp_f32 v91, v91
    v_smfmac_f32_32x32x32_bf16 v[144:159], v[16:19], v[80:87], v15
    s_waitcnt lgkmcnt(0)
    v_exp_f32 v92, v92
    v_exp_f32 v93, v93
    v_exp_f32 v94, v94
    v_exp_f32 v95, v95
    v_mfma_f32_32x32x16_bf16 v[64:79], v[48:51], v[192:195], 0
    s_add_u32 m0, s31, 50176
    s_add_u32 s30, s34, 50176
    buffer_load_dwordx4 v4, s[16:19], s30 offen offset:0 lds
    ds_read_b64_tr_b16 v[24:25], v8 offset:0
    v_exp_f32 v96, v96
    v_exp_f32 v97, v97
    v_exp_f32 v98, v98
    v_exp_f32 v99, v99
    v_mfma_f32_32x32x16_bf16 v[64:79], v[52:55], v[196:199], v[64:79]
    ds_read_b64_tr_b16 v[26:27], v8 offset:224
    v_exp_f32 v100, v100
    v_exp_f32 v101, v101
    v_exp_f32 v102, v102
    v_exp_f32 v103, v103
    v_smfmac_f32_32x32x32_bf16 v[144:159], v[20:23], v[88:95], v15
    buffer_load_dwordx4 v4, s[16:19], s30 offen offset:1024 lds
    ds_read_b64_tr_b16 v[28:29], v8 offset:896
    v_exp_f32 v104, v104
    v_exp_f32 v105, v105
    v_exp_f32 v106, v106
    v_exp_f32 v107, v107
    v_smfmac_f32_32x32x32_bf16 v[160:175], v[16:19], v[96:103], v15
    ds_read_b64_tr_b16 v[30:31], v8 offset:1120
    v_exp_f32 v108, v108
    v_exp_f32 v109, v109
    v_exp_f32 v110, v110
    v_exp_f32 v111, v111
    v_mfma_f32_32x32x16_bf16 v[80:95], v[48:51], v[200:203], 0
    v_exp_f32 v112, v112
    v_exp_f32 v113, v113
    v_exp_f32 v114, v114
    v_exp_f32 v115, v115
    v_mfma_f32_32x32x16_bf16 v[80:95], v[52:55], v[204:207], v[80:95]
    v_exp_f32 v116, v116
    v_exp_f32 v117, v117
    v_exp_f32 v118, v118
    v_exp_f32 v119, v119
    v_smfmac_f32_32x32x32_bf16 v[160:175], v[20:23], v[104:111], v15
    v_exp_f32 v120, v120
    v_exp_f32 v121, v121
    v_exp_f32 v122, v122
    v_exp_f32 v123, v123
    v_smfmac_f32_32x32x32_bf16 v[176:191], v[16:19], v[112:119], v15
    v_exp_f32 v124, v124
    v_exp_f32 v125, v125
    v_exp_f32 v126, v126
    v_exp_f32 v127, v127
    v_mfma_f32_32x32x16_bf16 v[96:111], v[48:51], v[208:211], 0
    ds_read_b64 v[40:41], v3 offset:21504
    v_exp_f32 v64, v64
    v_exp_f32 v65, v65
    v_exp_f32 v66, v66
    v_exp_f32 v67, v67
    v_mfma_f32_32x32x16_bf16 v[96:111], v[52:55], v[212:215], v[96:111]
    ds_read_b64 v[42:43], v3 offset:21512
    v_exp_f32 v68, v68
    v_exp_f32 v69, v69
    v_exp_f32 v70, v70
    v_exp_f32 v71, v71
    v_smfmac_f32_32x32x32_bf16 v[176:191], v[20:23], v[120:127], v15
    s_waitcnt lgkmcnt(4)
    ds_read_b64 v[44:45], v3 offset:21520
    v_exp_f32 v72, v72
    v_exp_f32 v73, v73
    v_exp_f32 v74, v74
    v_exp_f32 v75, v75
    v_smfmac_f32_32x32x32_bf16 v[128:143], v[24:27], v[64:71], v15
    ds_read_b64 v[46:47], v3 offset:21528
    v_exp_f32 v76, v76
    v_exp_f32 v77, v77
    v_exp_f32 v78, v78
    v_exp_f32 v79, v79
    v_mfma_f32_32x32x16_bf16 v[112:127], v[48:51], v[216:219], 0
    v_exp_f32 v80, v80
    v_exp_f32 v81, v81
    v_exp_f32 v82, v82
    v_exp_f32 v83, v83
    v_mfma_f32_32x32x16_bf16 v[112:127], v[52:55], v[220:223], v[112:127]
    s_waitcnt lgkmcnt(4)
    v_exp_f32 v84, v84
    v_exp_f32 v85, v85
    v_exp_f32 v86, v86
    v_exp_f32 v87, v87
    v_smfmac_f32_32x32x32_bf16 v[128:143], v[28:31], v[72:79], v15
    v_exp_f32 v88, v88
    v_exp_f32 v89, v89
    v_exp_f32 v90, v90
    v_exp_f32 v91, v91
    v_smfmac_f32_32x32x32_bf16 v[144:159], v[24:27], v[80:87], v15
    s_waitcnt lgkmcnt(0)
    s_setprio 2
    v_exp_f32 v92, v92
    v_exp_f32 v93, v93
    v_exp_f32 v94, v94
    v_exp_f32 v95, v95
    v_mfma_f32_32x32x16_bf16 v[64:79], v[40:43], v[192:195], 0
    ds_read_b64_tr_b16 v[16:17], v9 offset:0
    v_exp_f32 v96, v96
    v_exp_f32 v97, v97
    v_exp_f32 v98, v98
    v_exp_f32 v99, v99
    v_mfma_f32_32x32x16_bf16 v[64:79], v[44:47], v[196:199], v[64:79]
    ds_read_b64_tr_b16 v[18:19], v9 offset:224
    v_exp_f32 v100, v100
    v_exp_f32 v101, v101
    v_exp_f32 v102, v102
    v_exp_f32 v103, v103
    v_smfmac_f32_32x32x32_bf16 v[144:159], v[28:31], v[88:95], v15
    ds_read_b64_tr_b16 v[20:21], v9 offset:896
    v_exp_f32 v104, v104
    v_exp_f32 v105, v105
    v_exp_f32 v106, v106
    v_exp_f32 v107, v107
    v_smfmac_f32_32x32x32_bf16 v[160:175], v[24:27], v[96:103], v15
    ds_read_b64_tr_b16 v[22:23], v9 offset:1120
    v_exp_f32 v108, v108
    v_exp_f32 v109, v109
    v_exp_f32 v110, v110
    v_exp_f32 v111, v111
    v_mfma_f32_32x32x16_bf16 v[80:95], v[40:43], v[200:203], 0
    s_setprio 1
    v_exp_f32 v112, v112
    v_exp_f32 v113, v113
    v_exp_f32 v114, v114
    v_exp_f32 v115, v115
    v_mfma_f32_32x32x16_bf16 v[80:95], v[44:47], v[204:207], v[80:95]
    v_exp_f32 v116, v116
    v_exp_f32 v117, v117
    v_exp_f32 v118, v118
    v_exp_f32 v119, v119
    v_smfmac_f32_32x32x32_bf16 v[160:175], v[28:31], v[104:111], v15
    s_setprio 0
    v_exp_f32 v120, v120
    v_exp_f32 v121, v121
    v_exp_f32 v122, v122
    v_exp_f32 v123, v123
    v_smfmac_f32_32x32x32_bf16 v[176:191], v[24:27], v[112:119], v15
    s_waitcnt vmcnt(0)
    s_barrier
    s_setprio 3
    v_exp_f32 v124, v124
    v_exp_f32 v125, v125
    v_exp_f32 v126, v126
    v_exp_f32 v127, v127
    v_mfma_f32_32x32x16_bf16 v[96:111], v[40:43], v[208:211], 0
    s_add_u32 m0, s31, 0
    s_add_u32 s30, s34, 57344
    buffer_load_dwordx4 v4, s[16:19], s30 offen offset:0 lds
    ds_read_b64 v[48:49], v3 offset:28672
    v_exp_f32 v64, v64
    v_exp_f32 v65, v65
    v_exp_f32 v66, v66
    v_exp_f32 v67, v67
    v_mfma_f32_32x32x16_bf16 v[96:111], v[44:47], v[212:215], v[96:111]
    ds_read_b64 v[50:51], v3 offset:28680
    v_exp_f32 v68, v68
    v_exp_f32 v69, v69
    v_exp_f32 v70, v70
    v_exp_f32 v71, v71
    v_smfmac_f32_32x32x32_bf16 v[176:191], v[28:31], v[120:127], v15
    s_waitcnt lgkmcnt(4)
    buffer_load_dwordx4 v4, s[16:19], s30 offen offset:1024 lds
    ds_read_b64 v[52:53], v3 offset:28688
    v_exp_f32 v72, v72
    v_exp_f32 v73, v73
    v_exp_f32 v74, v74
    v_exp_f32 v75, v75
    v_smfmac_f32_32x32x32_bf16 v[128:143], v[16:19], v[64:71], v15
    ds_read_b64 v[54:55], v3 offset:28696
    v_exp_f32 v76, v76
    v_exp_f32 v77, v77
    v_exp_f32 v78, v78
    v_exp_f32 v79, v79
    v_mfma_f32_32x32x16_bf16 v[112:127], v[40:43], v[216:219], 0
    v_exp_f32 v80, v80
    v_exp_f32 v81, v81
    v_exp_f32 v82, v82
    v_exp_f32 v83, v83
    v_mfma_f32_32x32x16_bf16 v[112:127], v[44:47], v[220:223], v[112:127]
    s_waitcnt lgkmcnt(4)
    v_exp_f32 v84, v84
    v_exp_f32 v85, v85
    v_exp_f32 v86, v86
    v_exp_f32 v87, v87
    v_smfmac_f32_32x32x32_bf16 v[128:143], v[20:23], v[72:79], v15
    v_exp_f32 v88, v88
    v_exp_f32 v89, v89
    v_exp_f32 v90, v90
    v_exp_f32 v91, v91
    v_smfmac_f32_32x32x32_bf16 v[144:159], v[16:19], v[80:87], v15
    s_waitcnt lgkmcnt(0)
    v_exp_f32 v92, v92
    v_exp_f32 v93, v93
    v_exp_f32 v94, v94
    v_exp_f32 v95, v95
    v_mfma_f32_32x32x16_bf16 v[64:79], v[48:51], v[192:195], 0
    s_add_u32 m0, s31, 7168
    s_add_u32 s30, s34, 64512
    buffer_load_dwordx4 v4, s[16:19], s30 offen offset:0 lds
    ds_read_b64_tr_b16 v[24:25], v10 offset:0
    v_exp_f32 v96, v96
    v_exp_f32 v97, v97
    v_exp_f32 v98, v98
    v_exp_f32 v99, v99
    v_mfma_f32_32x32x16_bf16 v[64:79], v[52:55], v[196:199], v[64:79]
    ds_read_b64_tr_b16 v[26:27], v10 offset:224
    v_exp_f32 v100, v100
    v_exp_f32 v101, v101
    v_exp_f32 v102, v102
    v_exp_f32 v103, v103
    v_smfmac_f32_32x32x32_bf16 v[144:159], v[20:23], v[88:95], v15
    buffer_load_dwordx4 v4, s[16:19], s30 offen offset:1024 lds
    ds_read_b64_tr_b16 v[28:29], v10 offset:896
    v_exp_f32 v104, v104
    v_exp_f32 v105, v105
    v_exp_f32 v106, v106
    v_exp_f32 v107, v107
    v_smfmac_f32_32x32x32_bf16 v[160:175], v[16:19], v[96:103], v15
    ds_read_b64_tr_b16 v[30:31], v10 offset:1120
    v_exp_f32 v108, v108
    v_exp_f32 v109, v109
    v_exp_f32 v110, v110
    v_exp_f32 v111, v111
    v_mfma_f32_32x32x16_bf16 v[80:95], v[48:51], v[200:203], 0
    v_exp_f32 v112, v112
    v_exp_f32 v113, v113
    v_exp_f32 v114, v114
    v_exp_f32 v115, v115
    v_mfma_f32_32x32x16_bf16 v[80:95], v[52:55], v[204:207], v[80:95]
    v_exp_f32 v116, v116
    v_exp_f32 v117, v117
    v_exp_f32 v118, v118
    v_exp_f32 v119, v119
    v_smfmac_f32_32x32x32_bf16 v[160:175], v[20:23], v[104:111], v15
    v_exp_f32 v120, v120
    v_exp_f32 v121, v121
    v_exp_f32 v122, v122
    v_exp_f32 v123, v123
    v_smfmac_f32_32x32x32_bf16 v[176:191], v[16:19], v[112:119], v15
    v_exp_f32 v124, v124
    v_exp_f32 v125, v125
    v_exp_f32 v126, v126
    v_exp_f32 v127, v127
    v_mfma_f32_32x32x16_bf16 v[96:111], v[48:51], v[208:211], 0
    s_add_u32 m0, s31, 14336
    s_add_u32 s30, s34, 71680
    buffer_load_dwordx4 v4, s[16:19], s30 offen offset:0 lds
    ds_read_b64 v[40:41], v3 offset:35840
    v_exp_f32 v64, v64
    v_exp_f32 v65, v65
    v_exp_f32 v66, v66
    v_exp_f32 v67, v67
    v_mfma_f32_32x32x16_bf16 v[96:111], v[52:55], v[212:215], v[96:111]
    ds_read_b64 v[42:43], v3 offset:35848
    v_exp_f32 v68, v68
    v_exp_f32 v69, v69
    v_exp_f32 v70, v70
    v_exp_f32 v71, v71
    v_smfmac_f32_32x32x32_bf16 v[176:191], v[20:23], v[120:127], v15
    s_waitcnt lgkmcnt(4)
    buffer_load_dwordx4 v4, s[16:19], s30 offen offset:1024 lds
    ds_read_b64 v[44:45], v3 offset:35856
    v_exp_f32 v72, v72
    v_exp_f32 v73, v73
    v_exp_f32 v74, v74
    v_exp_f32 v75, v75
    v_smfmac_f32_32x32x32_bf16 v[128:143], v[24:27], v[64:71], v15
    ds_read_b64 v[46:47], v3 offset:35864
    v_exp_f32 v76, v76
    v_exp_f32 v77, v77
    v_exp_f32 v78, v78
    v_exp_f32 v79, v79
    v_mfma_f32_32x32x16_bf16 v[112:127], v[48:51], v[216:219], 0
    v_exp_f32 v80, v80
    v_exp_f32 v81, v81
    v_exp_f32 v82, v82
    v_exp_f32 v83, v83
    v_mfma_f32_32x32x16_bf16 v[112:127], v[52:55], v[220:223], v[112:127]
    s_waitcnt lgkmcnt(4)
    v_exp_f32 v84, v84
    v_exp_f32 v85, v85
    v_exp_f32 v86, v86
    v_exp_f32 v87, v87
    v_smfmac_f32_32x32x32_bf16 v[128:143], v[28:31], v[72:79], v15
    v_exp_f32 v88, v88
    v_exp_f32 v89, v89
    v_exp_f32 v90, v90
    v_exp_f32 v91, v91
    v_smfmac_f32_32x32x32_bf16 v[144:159], v[24:27], v[80:87], v15
    s_waitcnt lgkmcnt(0)
    v_exp_f32 v92, v92
    v_exp_f32 v93, v93
    v_exp_f32 v94, v94
    v_exp_f32 v95, v95
    v_mfma_f32_32x32x16_bf16 v[64:79], v[40:43], v[192:195], 0
    ds_read_b64_tr_b16 v[16:17], v11 offset:0
    v_exp_f32 v96, v96
    v_exp_f32 v97, v97
    v_exp_f32 v98, v98
    v_exp_f32 v99, v99
    v_mfma_f32_32x32x16_bf16 v[64:79], v[44:47], v[196:199], v[64:79]
    ds_read_b64_tr_b16 v[18:19], v11 offset:224
    v_exp_f32 v100, v100
    v_exp_f32 v101, v101
    v_exp_f32 v102, v102
    v_exp_f32 v103, v103
    v_smfmac_f32_32x32x32_bf16 v[144:159], v[28:31], v[88:95], v15
    ds_read_b64_tr_b16 v[20:21], v11 offset:896
    v_exp_f32 v104, v104
    v_exp_f32 v105, v105
    v_exp_f32 v106, v106
    v_exp_f32 v107, v107
    v_smfmac_f32_32x32x32_bf16 v[160:175], v[24:27], v[96:103], v15
    ds_read_b64_tr_b16 v[22:23], v11 offset:1120
    v_exp_f32 v108, v108
    v_exp_f32 v109, v109
    v_exp_f32 v110, v110
    v_exp_f32 v111, v111
    v_mfma_f32_32x32x16_bf16 v[80:95], v[40:43], v[200:203], 0
    v_exp_f32 v112, v112
    v_exp_f32 v113, v113
    v_exp_f32 v114, v114
    v_exp_f32 v115, v115
    v_mfma_f32_32x32x16_bf16 v[80:95], v[44:47], v[204:207], v[80:95]
    v_exp_f32 v116, v116
    v_exp_f32 v117, v117
    v_exp_f32 v118, v118
    v_exp_f32 v119, v119
    v_smfmac_f32_32x32x32_bf16 v[160:175], v[28:31], v[104:111], v15
    v_exp_f32 v120, v120
    v_exp_f32 v121, v121
    v_exp_f32 v122, v122
    v_exp_f32 v123, v123
    v_smfmac_f32_32x32x32_bf16 v[176:191], v[24:27], v[112:119], v15
    v_exp_f32 v124, v124
    v_exp_f32 v125, v125
    v_exp_f32 v126, v126
    v_exp_f32 v127, v127
    v_mfma_f32_32x32x16_bf16 v[96:111], v[40:43], v[208:211], 0
    ds_read_b64 v[48:49], v3 offset:43008
    v_exp_f32 v64, v64
    v_exp_f32 v65, v65
    v_exp_f32 v66, v66
    v_exp_f32 v67, v67
    v_mfma_f32_32x32x16_bf16 v[96:111], v[44:47], v[212:215], v[96:111]
    ds_read_b64 v[50:51], v3 offset:43016
    v_exp_f32 v68, v68
    v_exp_f32 v69, v69
    v_exp_f32 v70, v70
    v_exp_f32 v71, v71
    v_smfmac_f32_32x32x32_bf16 v[176:191], v[28:31], v[120:127], v15
    s_waitcnt lgkmcnt(4)
    ds_read_b64 v[52:53], v3 offset:43024
    v_exp_f32 v72, v72
    v_exp_f32 v73, v73
    v_exp_f32 v74, v74
    v_exp_f32 v75, v75
    v_smfmac_f32_32x32x32_bf16 v[128:143], v[16:19], v[64:71], v15
    ds_read_b64 v[54:55], v3 offset:43032
    v_exp_f32 v76, v76
    v_exp_f32 v77, v77
    v_exp_f32 v78, v78
    v_exp_f32 v79, v79
    v_mfma_f32_32x32x16_bf16 v[112:127], v[40:43], v[216:219], 0
    v_exp_f32 v80, v80
    v_exp_f32 v81, v81
    v_exp_f32 v82, v82
    v_exp_f32 v83, v83
    v_mfma_f32_32x32x16_bf16 v[112:127], v[44:47], v[220:223], v[112:127]
    s_waitcnt lgkmcnt(4)
    v_exp_f32 v84, v84
    v_exp_f32 v85, v85
    v_exp_f32 v86, v86
    v_exp_f32 v87, v87
    v_smfmac_f32_32x32x32_bf16 v[128:143], v[20:23], v[72:79], v15
    v_exp_f32 v88, v88
    v_exp_f32 v89, v89
    v_exp_f32 v90, v90
    v_exp_f32 v91, v91
    v_smfmac_f32_32x32x32_bf16 v[144:159], v[16:19], v[80:87], v15
    s_waitcnt lgkmcnt(0)
    v_exp_f32 v92, v92
    v_exp_f32 v93, v93
    v_exp_f32 v94, v94
    v_exp_f32 v95, v95
    v_mfma_f32_32x32x16_bf16 v[64:79], v[48:51], v[192:195], 0
    ds_read_b64_tr_b16 v[24:25], v12 offset:0
    v_exp_f32 v96, v96
    v_exp_f32 v97, v97
    v_exp_f32 v98, v98
    v_exp_f32 v99, v99
    v_mfma_f32_32x32x16_bf16 v[64:79], v[52:55], v[196:199], v[64:79]
    ds_read_b64_tr_b16 v[26:27], v12 offset:224
    v_exp_f32 v100, v100
    v_exp_f32 v101, v101
    v_exp_f32 v102, v102
    v_exp_f32 v103, v103
    v_smfmac_f32_32x32x32_bf16 v[144:159], v[20:23], v[88:95], v15
    ds_read_b64_tr_b16 v[28:29], v12 offset:896
    v_exp_f32 v104, v104
    v_exp_f32 v105, v105
    v_exp_f32 v106, v106
    v_exp_f32 v107, v107
    v_smfmac_f32_32x32x32_bf16 v[160:175], v[16:19], v[96:103], v15
    ds_read_b64_tr_b16 v[30:31], v12 offset:1120
    v_exp_f32 v108, v108
    v_exp_f32 v109, v109
    v_exp_f32 v110, v110
    v_exp_f32 v111, v111
    v_mfma_f32_32x32x16_bf16 v[80:95], v[48:51], v[200:203], 0
    v_exp_f32 v112, v112
    v_exp_f32 v113, v113
    v_exp_f32 v114, v114
    v_exp_f32 v115, v115
    v_mfma_f32_32x32x16_bf16 v[80:95], v[52:55], v[204:207], v[80:95]
    v_exp_f32 v116, v116
    v_exp_f32 v117, v117
    v_exp_f32 v118, v118
    v_exp_f32 v119, v119
    v_smfmac_f32_32x32x32_bf16 v[160:175], v[20:23], v[104:111], v15
    v_exp_f32 v120, v120
    v_exp_f32 v121, v121
    v_exp_f32 v122, v122
    v_exp_f32 v123, v123
    v_smfmac_f32_32x32x32_bf16 v[176:191], v[16:19], v[112:119], v15
    s_setprio 2
    v_exp_f32 v124, v124
    v_exp_f32 v125, v125
    v_exp_f32 v126, v126
    v_exp_f32 v127, v127
    v_mfma_f32_32x32x16_bf16 v[96:111], v[48:51], v[208:211], 0
    ds_read_b64 v[40:41], v3 offset:50176
    v_exp_f32 v64, v64
    v_exp_f32 v65, v65
    v_exp_f32 v66, v66
    v_exp_f32 v67, v67
    v_mfma_f32_32x32x16_bf16 v[96:111], v[52:55], v[212:215], v[96:111]
    ds_read_b64 v[42:43], v3 offset:50184
    v_exp_f32 v68, v68
    v_exp_f32 v69, v69
    v_exp_f32 v70, v70
    v_exp_f32 v71, v71
    v_smfmac_f32_32x32x32_bf16 v[176:191], v[20:23], v[120:127], v15
    s_waitcnt lgkmcnt(4)
    ds_read_b64 v[44:45], v3 offset:50192
    v_exp_f32 v72, v72
    v_exp_f32 v73, v73
    v_exp_f32 v74, v74
    v_exp_f32 v75, v75
    v_smfmac_f32_32x32x32_bf16 v[128:143], v[24:27], v[64:71], v15
    ds_read_b64 v[46:47], v3 offset:50200
    v_exp_f32 v76, v76
    v_exp_f32 v77, v77
    v_exp_f32 v78, v78
    v_exp_f32 v79, v79
    v_mfma_f32_32x32x16_bf16 v[112:127], v[48:51], v[216:219], 0
    v_exp_f32 v80, v80
    v_exp_f32 v81, v81
    v_exp_f32 v82, v82
    v_exp_f32 v83, v83
    v_mfma_f32_32x32x16_bf16 v[112:127], v[52:55], v[220:223], v[112:127]
    s_waitcnt lgkmcnt(4)
    v_exp_f32 v84, v84
    v_exp_f32 v85, v85
    v_exp_f32 v86, v86
    v_exp_f32 v87, v87
    v_smfmac_f32_32x32x32_bf16 v[128:143], v[28:31], v[72:79], v15
    v_exp_f32 v88, v88
    v_exp_f32 v89, v89
    v_exp_f32 v90, v90
    v_exp_f32 v91, v91
    v_smfmac_f32_32x32x32_bf16 v[144:159], v[24:27], v[80:87], v15
    s_waitcnt lgkmcnt(0)
    v_exp_f32 v92, v92
    v_exp_f32 v93, v93
    v_exp_f32 v94, v94
    v_exp_f32 v95, v95
    v_mfma_f32_32x32x16_bf16 v[64:79], v[40:43], v[192:195], 0
    ds_read_b64_tr_b16 v[16:17], v13 offset:0
    v_exp_f32 v96, v96
    v_exp_f32 v97, v97
    v_exp_f32 v98, v98
    v_exp_f32 v99, v99
    v_mfma_f32_32x32x16_bf16 v[64:79], v[44:47], v[196:199], v[64:79]
    ds_read_b64_tr_b16 v[18:19], v13 offset:224
    v_exp_f32 v100, v100
    v_exp_f32 v101, v101
    v_exp_f32 v102, v102
    v_exp_f32 v103, v103
    v_smfmac_f32_32x32x32_bf16 v[144:159], v[28:31], v[88:95], v15
    s_setprio 1
    ds_read_b64_tr_b16 v[20:21], v13 offset:896
    v_exp_f32 v104, v104
    v_exp_f32 v105, v105
    v_exp_f32 v106, v106
    v_exp_f32 v107, v107
    v_smfmac_f32_32x32x32_bf16 v[160:175], v[24:27], v[96:103], v15
    ds_read_b64_tr_b16 v[22:23], v13 offset:1120
    v_exp_f32 v108, v108
    v_exp_f32 v109, v109
    v_exp_f32 v110, v110
    v_exp_f32 v111, v111
    v_mfma_f32_32x32x16_bf16 v[80:95], v[40:43], v[200:203], 0
    v_exp_f32 v112, v112
    v_exp_f32 v113, v113
    v_exp_f32 v114, v114
    v_exp_f32 v115, v115
    v_mfma_f32_32x32x16_bf16 v[80:95], v[44:47], v[204:207], v[80:95]
    s_setprio 0
    v_exp_f32 v116, v116
    v_exp_f32 v117, v117
    v_exp_f32 v118, v118
    v_exp_f32 v119, v119
    v_smfmac_f32_32x32x32_bf16 v[160:175], v[28:31], v[104:111], v15
    v_exp_f32 v120, v120
    v_exp_f32 v121, v121
    v_exp_f32 v122, v122
    v_exp_f32 v123, v123
    v_smfmac_f32_32x32x32_bf16 v[176:191], v[24:27], v[112:119], v15
    s_waitcnt vmcnt(0)
    s_barrier
    s_setprio 3
    v_exp_f32 v124, v124
    v_exp_f32 v125, v125
    v_exp_f32 v126, v126
    v_exp_f32 v127, v127
    v_mfma_f32_32x32x16_bf16 v[96:111], v[40:43], v[208:211], 0
    s_add_u32 m0, s31, 21504
    s_add_u32 s30, s34, 78848
    buffer_load_dwordx4 v4, s[16:19], s30 offen offset:0 lds
    ds_read_b64 v[48:49], v3 offset:0
    v_exp_f32 v64, v64
    v_exp_f32 v65, v65
    v_exp_f32 v66, v66
    v_exp_f32 v67, v67
    v_mfma_f32_32x32x16_bf16 v[96:111], v[44:47], v[212:215], v[96:111]
    ds_read_b64 v[50:51], v3 offset:8
    v_exp_f32 v68, v68
    v_exp_f32 v69, v69
    v_exp_f32 v70, v70
    v_exp_f32 v71, v71
    v_smfmac_f32_32x32x32_bf16 v[176:191], v[28:31], v[120:127], v15
    s_waitcnt lgkmcnt(4)
    buffer_load_dwordx4 v4, s[16:19], s30 offen offset:1024 lds
    ds_read_b64 v[52:53], v3 offset:16
    v_exp_f32 v72, v72
    v_exp_f32 v73, v73
    v_exp_f32 v74, v74
    v_exp_f32 v75, v75
    v_smfmac_f32_32x32x32_bf16 v[128:143], v[16:19], v[64:71], v15
    ds_read_b64 v[54:55], v3 offset:24
    v_exp_f32 v76, v76
    v_exp_f32 v77, v77
    v_exp_f32 v78, v78
    v_exp_f32 v79, v79
    v_mfma_f32_32x32x16_bf16 v[112:127], v[40:43], v[216:219], 0
    s_add_u32 m0, s31, 28672
    s_add_u32 s30, s34, 86016
    buffer_load_dwordx4 v4, s[16:19], s30 offen offset:0 lds
    v_exp_f32 v80, v80
    v_exp_f32 v81, v81
    v_exp_f32 v82, v82
    v_exp_f32 v83, v83
    v_mfma_f32_32x32x16_bf16 v[112:127], v[44:47], v[220:223], v[112:127]
    s_waitcnt lgkmcnt(4)
    v_exp_f32 v84, v84
    v_exp_f32 v85, v85
    v_exp_f32 v86, v86
    v_exp_f32 v87, v87
    v_smfmac_f32_32x32x32_bf16 v[128:143], v[20:23], v[72:79], v15
    buffer_load_dwordx4 v4, s[16:19], s30 offen offset:1024 lds
    v_exp_f32 v88, v88
    v_exp_f32 v89, v89
    v_exp_f32 v90, v90
    v_exp_f32 v91, v91
    v_smfmac_f32_32x32x32_bf16 v[144:159], v[16:19], v[80:87], v15
    s_waitcnt lgkmcnt(0)
    v_exp_f32 v92, v92
    v_exp_f32 v93, v93
    v_exp_f32 v94, v94
    v_exp_f32 v95, v95
    v_mfma_f32_32x32x16_bf16 v[64:79], v[48:51], v[192:195], 0
    s_add_u32 m0, s31, 35840
    s_add_u32 s30, s34, 93184
    buffer_load_dwordx4 v4, s[16:19], s30 offen offset:0 lds
    ds_read_b64_tr_b16 v[24:25], v6 offset:0
    v_exp_f32 v96, v96
    v_exp_f32 v97, v97
    v_exp_f32 v98, v98
    v_exp_f32 v99, v99
    v_mfma_f32_32x32x16_bf16 v[64:79], v[52:55], v[196:199], v[64:79]
    ds_read_b64_tr_b16 v[26:27], v6 offset:224
    v_exp_f32 v100, v100
    v_exp_f32 v101, v101
    v_exp_f32 v102, v102
    v_exp_f32 v103, v103
    v_smfmac_f32_32x32x32_bf16 v[144:159], v[20:23], v[88:95], v15
    buffer_load_dwordx4 v4, s[16:19], s30 offen offset:1024 lds
    ds_read_b64_tr_b16 v[28:29], v6 offset:896
    v_exp_f32 v104, v104
    v_exp_f32 v105, v105
    v_exp_f32 v106, v106
    v_exp_f32 v107, v107
    v_smfmac_f32_32x32x32_bf16 v[160:175], v[16:19], v[96:103], v15
    ds_read_b64_tr_b16 v[30:31], v6 offset:1120
    v_exp_f32 v108, v108
    v_exp_f32 v109, v109
    v_exp_f32 v110, v110
    v_exp_f32 v111, v111
    v_mfma_f32_32x32x16_bf16 v[80:95], v[48:51], v[200:203], 0
    s_add_u32 m0, s31, 43008
    s_add_u32 s30, s34, 100352
    buffer_load_dwordx4 v4, s[16:19], s30 offen offset:0 lds
    v_exp_f32 v112, v112
    v_exp_f32 v113, v113
    v_exp_f32 v114, v114
    v_exp_f32 v115, v115
    v_mfma_f32_32x32x16_bf16 v[80:95], v[52:55], v[204:207], v[80:95]
    v_exp_f32 v116, v116
    v_exp_f32 v117, v117
    v_exp_f32 v118, v118
    v_exp_f32 v119, v119
    v_smfmac_f32_32x32x32_bf16 v[160:175], v[20:23], v[104:111], v15
    buffer_load_dwordx4 v4, s[16:19], s30 offen offset:1024 lds
    v_exp_f32 v120, v120
    v_exp_f32 v121, v121
    v_exp_f32 v122, v122
    v_exp_f32 v123, v123
    v_smfmac_f32_32x32x32_bf16 v[176:191], v[16:19], v[112:119], v15
    v_exp_f32 v124, v124
    v_exp_f32 v125, v125
    v_exp_f32 v126, v126
    v_exp_f32 v127, v127
    v_mfma_f32_32x32x16_bf16 v[96:111], v[48:51], v[208:211], 0
    ds_read_b64 v[40:41], v3 offset:7168
    v_exp_f32 v64, v64
    v_exp_f32 v65, v65
    v_exp_f32 v66, v66
    v_exp_f32 v67, v67
    v_mfma_f32_32x32x16_bf16 v[96:111], v[52:55], v[212:215], v[96:111]
    ds_read_b64 v[42:43], v3 offset:7176
    v_exp_f32 v68, v68
    v_exp_f32 v69, v69
    v_exp_f32 v70, v70
    v_exp_f32 v71, v71
    v_smfmac_f32_32x32x32_bf16 v[176:191], v[20:23], v[120:127], v15
    s_waitcnt lgkmcnt(4)
    ds_read_b64 v[44:45], v3 offset:7184
    v_exp_f32 v72, v72
    v_exp_f32 v73, v73
    v_exp_f32 v74, v74
    v_exp_f32 v75, v75
    v_smfmac_f32_32x32x32_bf16 v[128:143], v[24:27], v[64:71], v15
    ds_read_b64 v[46:47], v3 offset:7192
    v_exp_f32 v76, v76
    v_exp_f32 v77, v77
    v_exp_f32 v78, v78
    v_exp_f32 v79, v79
    v_mfma_f32_32x32x16_bf16 v[112:127], v[48:51], v[216:219], 0
    v_exp_f32 v80, v80
    v_exp_f32 v81, v81
    v_exp_f32 v82, v82
    v_exp_f32 v83, v83
    v_mfma_f32_32x32x16_bf16 v[112:127], v[52:55], v[220:223], v[112:127]
    s_waitcnt lgkmcnt(4)
    v_exp_f32 v84, v84
    v_exp_f32 v85, v85
    v_exp_f32 v86, v86
    v_exp_f32 v87, v87
    v_smfmac_f32_32x32x32_bf16 v[128:143], v[28:31], v[72:79], v15
    v_exp_f32 v88, v88
    v_exp_f32 v89, v89
    v_exp_f32 v90, v90
    v_exp_f32 v91, v91
    v_smfmac_f32_32x32x32_bf16 v[144:159], v[24:27], v[80:87], v15
    s_waitcnt lgkmcnt(0)
    v_exp_f32 v92, v92
    v_exp_f32 v93, v93
    v_exp_f32 v94, v94
    v_exp_f32 v95, v95
    v_mfma_f32_32x32x16_bf16 v[64:79], v[40:43], v[192:195], 0
    ds_read_b64_tr_b16 v[16:17], v7 offset:0
    v_exp_f32 v96, v96
    v_exp_f32 v97, v97
    v_exp_f32 v98, v98
    v_exp_f32 v99, v99
    v_mfma_f32_32x32x16_bf16 v[64:79], v[44:47], v[196:199], v[64:79]
    ds_read_b64_tr_b16 v[18:19], v7 offset:224
    v_exp_f32 v100, v100
    v_exp_f32 v101, v101
    v_exp_f32 v102, v102
    v_exp_f32 v103, v103
    v_smfmac_f32_32x32x32_bf16 v[144:159], v[28:31], v[88:95], v15
    ds_read_b64_tr_b16 v[20:21], v7 offset:896
    v_exp_f32 v104, v104
    v_exp_f32 v105, v105
    v_exp_f32 v106, v106
    v_exp_f32 v107, v107
    v_smfmac_f32_32x32x32_bf16 v[160:175], v[24:27], v[96:103], v15
    ds_read_b64_tr_b16 v[22:23], v7 offset:1120
    v_exp_f32 v108, v108
    v_exp_f32 v109, v109
    v_exp_f32 v110, v110
    v_exp_f32 v111, v111
    v_mfma_f32_32x32x16_bf16 v[80:95], v[40:43], v[200:203], 0
    v_exp_f32 v112, v112
    v_exp_f32 v113, v113
    v_exp_f32 v114, v114
    v_exp_f32 v115, v115
    v_mfma_f32_32x32x16_bf16 v[80:95], v[44:47], v[204:207], v[80:95]
    v_exp_f32 v116, v116
    v_exp_f32 v117, v117
    v_exp_f32 v118, v118
    v_exp_f32 v119, v119
    v_smfmac_f32_32x32x32_bf16 v[160:175], v[28:31], v[104:111], v15
    v_exp_f32 v120, v120
    v_exp_f32 v121, v121
    v_exp_f32 v122, v122
    v_exp_f32 v123, v123
    v_smfmac_f32_32x32x32_bf16 v[176:191], v[24:27], v[112:119], v15
    v_exp_f32 v124, v124
    v_exp_f32 v125, v125
    v_exp_f32 v126, v126
    v_exp_f32 v127, v127
    v_mfma_f32_32x32x16_bf16 v[96:111], v[40:43], v[208:211], 0
    ds_read_b64 v[48:49], v3 offset:14336
    v_exp_f32 v64, v64
    v_exp_f32 v65, v65
    v_exp_f32 v66, v66
    v_exp_f32 v67, v67
    v_mfma_f32_32x32x16_bf16 v[96:111], v[44:47], v[212:215], v[96:111]
    ds_read_b64 v[50:51], v3 offset:14344
    v_exp_f32 v68, v68
    v_exp_f32 v69, v69
    v_exp_f32 v70, v70
    v_exp_f32 v71, v71
    v_smfmac_f32_32x32x32_bf16 v[176:191], v[28:31], v[120:127], v15
    s_waitcnt lgkmcnt(4)
    ds_read_b64 v[52:53], v3 offset:14352
    v_exp_f32 v72, v72
    v_exp_f32 v73, v73
    v_exp_f32 v74, v74
    v_exp_f32 v75, v75
    v_smfmac_f32_32x32x32_bf16 v[128:143], v[16:19], v[64:71], v15
    s_setprio 2
    ds_read_b64 v[54:55], v3 offset:14360
    v_exp_f32 v76, v76
    v_exp_f32 v77, v77
    v_exp_f32 v78, v78
    v_exp_f32 v79, v79
    v_mfma_f32_32x32x16_bf16 v[112:127], v[40:43], v[216:219], 0
    v_exp_f32 v80, v80
    v_exp_f32 v81, v81
    v_exp_f32 v82, v82
    v_exp_f32 v83, v83
    v_mfma_f32_32x32x16_bf16 v[112:127], v[44:47], v[220:223], v[112:127]
    s_waitcnt lgkmcnt(4)
    v_exp_f32 v84, v84
    v_exp_f32 v85, v85
    v_exp_f32 v86, v86
    v_exp_f32 v87, v87
    v_smfmac_f32_32x32x32_bf16 v[128:143], v[20:23], v[72:79], v15
    v_exp_f32 v88, v88
    v_exp_f32 v89, v89
    v_exp_f32 v90, v90
    v_exp_f32 v91, v91
    v_smfmac_f32_32x32x32_bf16 v[144:159], v[16:19], v[80:87], v15
    s_waitcnt lgkmcnt(0)
    v_exp_f32 v92, v92
    v_exp_f32 v93, v93
    v_exp_f32 v94, v94
    v_exp_f32 v95, v95
    v_mfma_f32_32x32x16_bf16 v[64:79], v[48:51], v[192:195], 0
    ds_read_b64_tr_b16 v[24:25], v8 offset:0
    v_exp_f32 v96, v96
    v_exp_f32 v97, v97
    v_exp_f32 v98, v98
    v_exp_f32 v99, v99
    v_mfma_f32_32x32x16_bf16 v[64:79], v[52:55], v[196:199], v[64:79]
    ds_read_b64_tr_b16 v[26:27], v8 offset:224
    v_exp_f32 v100, v100
    v_exp_f32 v101, v101
    v_exp_f32 v102, v102
    v_exp_f32 v103, v103
    v_smfmac_f32_32x32x32_bf16 v[144:159], v[20:23], v[88:95], v15
    ds_read_b64_tr_b16 v[28:29], v8 offset:896
    v_exp_f32 v104, v104
    v_exp_f32 v105, v105
    v_exp_f32 v106, v106
    v_exp_f32 v107, v107
    v_smfmac_f32_32x32x32_bf16 v[160:175], v[16:19], v[96:103], v15
    s_setprio 1
    ds_read_b64_tr_b16 v[30:31], v8 offset:1120
    v_exp_f32 v108, v108
    v_exp_f32 v109, v109
    v_exp_f32 v110, v110
    v_exp_f32 v111, v111
    v_mfma_f32_32x32x16_bf16 v[80:95], v[48:51], v[200:203], 0
    v_exp_f32 v112, v112
    v_exp_f32 v113, v113
    v_exp_f32 v114, v114
    v_exp_f32 v115, v115
    v_mfma_f32_32x32x16_bf16 v[80:95], v[52:55], v[204:207], v[80:95]
    v_exp_f32 v116, v116
    v_exp_f32 v117, v117
    v_exp_f32 v118, v118
    v_exp_f32 v119, v119
    v_smfmac_f32_32x32x32_bf16 v[160:175], v[20:23], v[104:111], v15
    s_setprio 0
    v_exp_f32 v120, v120
    v_exp_f32 v121, v121
    v_exp_f32 v122, v122
    v_exp_f32 v123, v123
    v_smfmac_f32_32x32x32_bf16 v[176:191], v[16:19], v[112:119], v15
    s_waitcnt vmcnt(0)
    s_barrier
    s_setprio 3
    v_exp_f32 v124, v124
    v_exp_f32 v125, v125
    v_exp_f32 v126, v126
    v_exp_f32 v127, v127
    v_mfma_f32_32x32x16_bf16 v[96:111], v[48:51], v[208:211], 0
    s_add_u32 m0, s31, 50176
    s_add_u32 s30, s34, 107520
    buffer_load_dwordx4 v4, s[16:19], s30 offen offset:0 lds
    ds_read_b64 v[40:41], v3 offset:21504
    v_exp_f32 v64, v64
    v_exp_f32 v65, v65
    v_exp_f32 v66, v66
    v_exp_f32 v67, v67
    v_mfma_f32_32x32x16_bf16 v[96:111], v[52:55], v[212:215], v[96:111]
    ds_read_b64 v[42:43], v3 offset:21512
    v_exp_f32 v68, v68
    v_exp_f32 v69, v69
    v_exp_f32 v70, v70
    v_exp_f32 v71, v71
    v_smfmac_f32_32x32x32_bf16 v[176:191], v[20:23], v[120:127], v15
    s_waitcnt lgkmcnt(4)
    buffer_load_dwordx4 v4, s[16:19], s30 offen offset:1024 lds
    ds_read_b64 v[44:45], v3 offset:21520
    v_exp_f32 v72, v72
    v_exp_f32 v73, v73
    v_exp_f32 v74, v74
    v_exp_f32 v75, v75
    v_smfmac_f32_32x32x32_bf16 v[128:143], v[24:27], v[64:71], v15
    ds_read_b64 v[46:47], v3 offset:21528
    v_exp_f32 v76, v76
    v_exp_f32 v77, v77
    v_exp_f32 v78, v78
    v_exp_f32 v79, v79
    v_mfma_f32_32x32x16_bf16 v[112:127], v[48:51], v[216:219], 0
    v_exp_f32 v80, v80
    v_exp_f32 v81, v81
    v_exp_f32 v82, v82
    v_exp_f32 v83, v83
    v_mfma_f32_32x32x16_bf16 v[112:127], v[52:55], v[220:223], v[112:127]
    s_waitcnt lgkmcnt(4)
    v_exp_f32 v84, v84
    v_exp_f32 v85, v85
    v_exp_f32 v86, v86
    v_exp_f32 v87, v87
    v_smfmac_f32_32x32x32_bf16 v[128:143], v[28:31], v[72:79], v15
    v_exp_f32 v88, v88
    v_exp_f32 v89, v89
    v_exp_f32 v90, v90
    v_exp_f32 v91, v91
    v_smfmac_f32_32x32x32_bf16 v[144:159], v[24:27], v[80:87], v15
    s_waitcnt lgkmcnt(0)
    v_exp_f32 v92, v92
    v_exp_f32 v93, v93
    v_exp_f32 v94, v94
    v_exp_f32 v95, v95
    v_mfma_f32_32x32x16_bf16 v[64:79], v[40:43], v[192:195], 0
    ds_read_b64_tr_b16 v[16:17], v9 offset:0
    v_exp_f32 v96, v96
    v_exp_f32 v97, v97
    v_exp_f32 v98, v98
    v_exp_f32 v99, v99
    v_mfma_f32_32x32x16_bf16 v[64:79], v[44:47], v[196:199], v[64:79]
    ds_read_b64_tr_b16 v[18:19], v9 offset:224
    v_exp_f32 v100, v100
    v_exp_f32 v101, v101
    v_exp_f32 v102, v102
    v_exp_f32 v103, v103
    v_smfmac_f32_32x32x32_bf16 v[144:159], v[28:31], v[88:95], v15
    ds_read_b64_tr_b16 v[20:21], v9 offset:896
    v_exp_f32 v104, v104
    v_exp_f32 v105, v105
    v_exp_f32 v106, v106
    v_exp_f32 v107, v107
    v_smfmac_f32_32x32x32_bf16 v[160:175], v[24:27], v[96:103], v15
    ds_read_b64_tr_b16 v[22:23], v9 offset:1120
    v_exp_f32 v108, v108
    v_exp_f32 v109, v109
    v_exp_f32 v110, v110
    v_exp_f32 v111, v111
    v_mfma_f32_32x32x16_bf16 v[80:95], v[40:43], v[200:203], 0
    v_exp_f32 v112, v112
    v_exp_f32 v113, v113
    v_exp_f32 v114, v114
    v_exp_f32 v115, v115
    v_mfma_f32_32x32x16_bf16 v[80:95], v[44:47], v[204:207], v[80:95]
    v_exp_f32 v116, v116
    v_exp_f32 v117, v117
    v_exp_f32 v118, v118
    v_exp_f32 v119, v119
    v_smfmac_f32_32x32x32_bf16 v[160:175], v[28:31], v[104:111], v15
    v_exp_f32 v120, v120
    v_exp_f32 v121, v121
    v_exp_f32 v122, v122
    v_exp_f32 v123, v123
    v_smfmac_f32_32x32x32_bf16 v[176:191], v[24:27], v[112:119], v15
    v_exp_f32 v124, v124
    v_exp_f32 v125, v125
    v_exp_f32 v126, v126
    v_exp_f32 v127, v127
    v_mfma_f32_32x32x16_bf16 v[96:111], v[40:43], v[208:211], 0
    ds_read_b64 v[48:49], v3 offset:28672
    v_exp_f32 v64, v64
    v_exp_f32 v65, v65
    v_exp_f32 v66, v66
    v_exp_f32 v67, v67
    v_mfma_f32_32x32x16_bf16 v[96:111], v[44:47], v[212:215], v[96:111]
    ds_read_b64 v[50:51], v3 offset:28680
    v_exp_f32 v68, v68
    v_exp_f32 v69, v69
    v_exp_f32 v70, v70
    v_exp_f32 v71, v71
    v_smfmac_f32_32x32x32_bf16 v[176:191], v[28:31], v[120:127], v15
    s_waitcnt lgkmcnt(4)
    ds_read_b64 v[52:53], v3 offset:28688
    v_exp_f32 v72, v72
    v_exp_f32 v73, v73
    v_exp_f32 v74, v74
    v_exp_f32 v75, v75
    v_smfmac_f32_32x32x32_bf16 v[128:143], v[16:19], v[64:71], v15
    ds_read_b64 v[54:55], v3 offset:28696
    v_exp_f32 v76, v76
    v_exp_f32 v77, v77
    v_exp_f32 v78, v78
    v_exp_f32 v79, v79
    v_mfma_f32_32x32x16_bf16 v[112:127], v[40:43], v[216:219], 0
    v_exp_f32 v80, v80
    v_exp_f32 v81, v81
    v_exp_f32 v82, v82
    v_exp_f32 v83, v83
    v_mfma_f32_32x32x16_bf16 v[112:127], v[44:47], v[220:223], v[112:127]
    s_waitcnt lgkmcnt(4)
    v_exp_f32 v84, v84
    v_exp_f32 v85, v85
    v_exp_f32 v86, v86
    v_exp_f32 v87, v87
    v_smfmac_f32_32x32x32_bf16 v[128:143], v[20:23], v[72:79], v15
    v_exp_f32 v88, v88
    v_exp_f32 v89, v89
    v_exp_f32 v90, v90
    v_exp_f32 v91, v91
    v_smfmac_f32_32x32x32_bf16 v[144:159], v[16:19], v[80:87], v15
    s_waitcnt lgkmcnt(0)
    s_setprio 2
    v_exp_f32 v92, v92
    v_exp_f32 v93, v93
    v_exp_f32 v94, v94
    v_exp_f32 v95, v95
    v_mfma_f32_32x32x16_bf16 v[64:79], v[48:51], v[192:195], 0
    ds_read_b64_tr_b16 v[24:25], v10 offset:0
    v_exp_f32 v96, v96
    v_exp_f32 v97, v97
    v_exp_f32 v98, v98
    v_exp_f32 v99, v99
    v_mfma_f32_32x32x16_bf16 v[64:79], v[52:55], v[196:199], v[64:79]
    ds_read_b64_tr_b16 v[26:27], v10 offset:224
    v_exp_f32 v100, v100
    v_exp_f32 v101, v101
    v_exp_f32 v102, v102
    v_exp_f32 v103, v103
    v_smfmac_f32_32x32x32_bf16 v[144:159], v[20:23], v[88:95], v15
    ds_read_b64_tr_b16 v[28:29], v10 offset:896
    v_exp_f32 v104, v104
    v_exp_f32 v105, v105
    v_exp_f32 v106, v106
    v_exp_f32 v107, v107
    v_smfmac_f32_32x32x32_bf16 v[160:175], v[16:19], v[96:103], v15
    ds_read_b64_tr_b16 v[30:31], v10 offset:1120
    v_exp_f32 v108, v108
    v_exp_f32 v109, v109
    v_exp_f32 v110, v110
    v_exp_f32 v111, v111
    v_mfma_f32_32x32x16_bf16 v[80:95], v[48:51], v[200:203], 0
    s_setprio 1
    v_exp_f32 v112, v112
    v_exp_f32 v113, v113
    v_exp_f32 v114, v114
    v_exp_f32 v115, v115
    v_mfma_f32_32x32x16_bf16 v[80:95], v[52:55], v[204:207], v[80:95]
    v_exp_f32 v116, v116
    v_exp_f32 v117, v117
    v_exp_f32 v118, v118
    v_exp_f32 v119, v119
    v_smfmac_f32_32x32x32_bf16 v[160:175], v[20:23], v[104:111], v15
    s_setprio 0
    v_exp_f32 v120, v120
    v_exp_f32 v121, v121
    v_exp_f32 v122, v122
    v_exp_f32 v123, v123
    v_smfmac_f32_32x32x32_bf16 v[176:191], v[16:19], v[112:119], v15
    s_waitcnt vmcnt(0)
    s_barrier
    s_setprio 3
    v_exp_f32 v124, v124
    v_exp_f32 v125, v125
    v_exp_f32 v126, v126
    v_exp_f32 v127, v127
    v_mfma_f32_32x32x16_bf16 v[96:111], v[48:51], v[208:211], 0
    ds_read_b64 v[40:41], v3 offset:35840
    v_exp_f32 v64, v64
    v_exp_f32 v65, v65
    v_exp_f32 v66, v66
    v_exp_f32 v67, v67
    v_mfma_f32_32x32x16_bf16 v[96:111], v[52:55], v[212:215], v[96:111]
    ds_read_b64 v[42:43], v3 offset:35848
    v_exp_f32 v68, v68
    v_exp_f32 v69, v69
    v_exp_f32 v70, v70
    v_exp_f32 v71, v71
    v_smfmac_f32_32x32x32_bf16 v[176:191], v[20:23], v[120:127], v15
    s_waitcnt lgkmcnt(4)
    ds_read_b64 v[44:45], v3 offset:35856
    v_exp_f32 v72, v72
    v_exp_f32 v73, v73
    v_exp_f32 v74, v74
    v_exp_f32 v75, v75
    v_smfmac_f32_32x32x32_bf16 v[128:143], v[24:27], v[64:71], v15
    ds_read_b64 v[46:47], v3 offset:35864
    v_exp_f32 v76, v76
    v_exp_f32 v77, v77
    v_exp_f32 v78, v78
    v_exp_f32 v79, v79
    v_mfma_f32_32x32x16_bf16 v[112:127], v[48:51], v[216:219], 0
    ds_read_b64 v[56:57], v3 offset:43008
    v_exp_f32 v80, v80
    v_exp_f32 v81, v81
    v_exp_f32 v82, v82
    v_exp_f32 v83, v83
    v_mfma_f32_32x32x16_bf16 v[112:127], v[52:55], v[220:223], v[112:127]
    s_waitcnt lgkmcnt(5)
    ds_read_b64 v[58:59], v3 offset:43016
    v_exp_f32 v84, v84
    v_exp_f32 v85, v85
    v_exp_f32 v86, v86
    v_exp_f32 v87, v87
    v_smfmac_f32_32x32x32_bf16 v[128:143], v[28:31], v[72:79], v15
    ds_read_b64 v[60:61], v3 offset:43024
    v_exp_f32 v88, v88
    v_exp_f32 v89, v89
    v_exp_f32 v90, v90
    v_exp_f32 v91, v91
    v_smfmac_f32_32x32x32_bf16 v[144:159], v[24:27], v[80:87], v15
    s_waitcnt lgkmcnt(3)
    ds_read_b64 v[62:63], v3 offset:43032
    v_exp_f32 v92, v92
    v_exp_f32 v93, v93
    v_exp_f32 v94, v94
    v_exp_f32 v95, v95
    v_mfma_f32_32x32x16_bf16 v[64:79], v[40:43], v[192:195], 0
    ds_read_b64_tr_b16 v[16:17], v11 offset:0
    v_exp_f32 v96, v96
    v_exp_f32 v97, v97
    v_exp_f32 v98, v98
    v_exp_f32 v99, v99
    v_mfma_f32_32x32x16_bf16 v[64:79], v[44:47], v[196:199], v[64:79]
    ds_read_b64_tr_b16 v[18:19], v11 offset:224
    v_exp_f32 v100, v100
    v_exp_f32 v101, v101
    v_exp_f32 v102, v102
    v_exp_f32 v103, v103
    v_smfmac_f32_32x32x32_bf16 v[144:159], v[28:31], v[88:95], v15
    ds_read_b64_tr_b16 v[20:21], v11 offset:896
    ds_read_b64 v[48:49], v3 offset:50176
    v_exp_f32 v104, v104
    v_exp_f32 v105, v105
    v_exp_f32 v106, v106
    v_exp_f32 v107, v107
    v_smfmac_f32_32x32x32_bf16 v[160:175], v[24:27], v[96:103], v15
    s_waitcnt lgkmcnt(4)
    ds_read_b64_tr_b16 v[22:23], v11 offset:1120
    ds_read_b64 v[50:51], v3 offset:50184
    v_exp_f32 v108, v108
    v_exp_f32 v109, v109
    v_exp_f32 v110, v110
    v_exp_f32 v111, v111
    v_mfma_f32_32x32x16_bf16 v[80:95], v[56:59], v[192:195], 0
    ds_read_b64 v[52:53], v3 offset:50192
    v_exp_f32 v112, v112
    v_exp_f32 v113, v113
    v_exp_f32 v114, v114
    v_exp_f32 v115, v115
    v_mfma_f32_32x32x16_bf16 v[80:95], v[60:63], v[196:199], v[80:95]
    ds_read_b64 v[54:55], v3 offset:50200
    v_exp_f32 v116, v116
    v_exp_f32 v117, v117
    v_exp_f32 v118, v118
    v_exp_f32 v119, v119
    v_smfmac_f32_32x32x32_bf16 v[160:175], v[28:31], v[104:111], v15
    ds_read_b64_tr_b16 v[32:33], v12 offset:0
    v_exp_f32 v120, v120
    v_exp_f32 v121, v121
    v_exp_f32 v122, v122
    v_exp_f32 v123, v123
    v_smfmac_f32_32x32x32_bf16 v[176:191], v[24:27], v[112:119], v15
    s_waitcnt lgkmcnt(1)
    ds_read_b64_tr_b16 v[34:35], v12 offset:224
    v_exp_f32 v124, v124
    v_exp_f32 v125, v125
    v_exp_f32 v126, v126
    v_exp_f32 v127, v127
    v_mfma_f32_32x32x16_bf16 v[96:111], v[48:51], v[192:195], 0
    ds_read_b64_tr_b16 v[36:37], v12 offset:896
    v_exp_f32 v64, v64
    v_exp_f32 v65, v65
    v_exp_f32 v66, v66
    v_exp_f32 v67, v67
    v_mfma_f32_32x32x16_bf16 v[96:111], v[52:55], v[196:199], v[96:111]
    s_setprio 2
    ds_read_b64_tr_b16 v[38:39], v12 offset:1120
    v_exp_f32 v68, v68
    v_exp_f32 v69, v69
    v_exp_f32 v70, v70
    v_exp_f32 v71, v71
    v_smfmac_f32_32x32x32_bf16 v[176:191], v[28:31], v[120:127], v15
    v_exp_f32 v72, v72
    v_exp_f32 v73, v73
    v_exp_f32 v74, v74
    v_exp_f32 v75, v75
    v_smfmac_f32_32x32x32_bf16 v[128:143], v[16:19], v[64:71], v15
    v_exp_f32 v76, v76
    v_exp_f32 v77, v77
    v_exp_f32 v78, v78
    v_exp_f32 v79, v79
    v_mfma_f32_32x32x16_bf16 v[112:127], v[40:43], v[200:203], 0
    ds_read_b64_tr_b16 v[24:25], v13 offset:0
    v_exp_f32 v80, v80
    v_exp_f32 v81, v81
    v_exp_f32 v82, v82
    v_exp_f32 v83, v83
    v_mfma_f32_32x32x16_bf16 v[112:127], v[44:47], v[204:207], v[112:127]
    s_setprio 1
    ds_read_b64_tr_b16 v[26:27], v13 offset:224
    v_exp_f32 v84, v84
    v_exp_f32 v85, v85
    v_exp_f32 v86, v86
    v_exp_f32 v87, v87
    v_smfmac_f32_32x32x32_bf16 v[128:143], v[20:23], v[72:79], v15
    s_waitcnt lgkmcnt(4)
    s_setprio 0
    ds_read_b64_tr_b16 v[28:29], v13 offset:896
    v_exp_f32 v88, v88
    v_exp_f32 v89, v89
    v_exp_f32 v90, v90
    v_exp_f32 v91, v91
    v_smfmac_f32_32x32x32_bf16 v[128:143], v[32:35], v[80:87], v15
    ds_read_b64_tr_b16 v[30:31], v13 offset:1120
    s_barrier
    s_setprio 3
    v_exp_f32 v92, v92
    v_exp_f32 v93, v93
    v_exp_f32 v94, v94
    v_exp_f32 v95, v95
    v_mfma_f32_32x32x16_bf16 v[64:79], v[56:59], v[200:203], 0
    v_subrev_u32 v0, 118784, v0
    v_exp_f32 v96, v96
    v_exp_f32 v97, v97
    v_exp_f32 v98, v98
    v_exp_f32 v99, v99
    v_mfma_f32_32x32x16_bf16 v[64:79], v[60:63], v[204:207], v[64:79]
    s_waitcnt lgkmcnt(4)
    v_subrev_u32 v1, 61440, v1
    v_exp_f32 v100, v100
    v_exp_f32 v101, v101
    v_exp_f32 v102, v102
    v_exp_f32 v103, v103
    v_smfmac_f32_32x32x32_bf16 v[128:143], v[36:39], v[88:95], v15
    s_waitcnt lgkmcnt(2)
    v_exp_f32 v104, v104
    v_exp_f32 v105, v105
    v_exp_f32 v106, v106
    v_exp_f32 v107, v107
    v_smfmac_f32_32x32x32_bf16 v[128:143], v[24:27], v[96:103], v15
    v_exp_f32 v108, v108
    v_exp_f32 v109, v109
    v_exp_f32 v110, v110
    v_exp_f32 v111, v111
    v_mfma_f32_32x32x16_bf16 v[80:95], v[48:51], v[200:203], 0
    v_exp_f32 v112, v112
    v_exp_f32 v113, v113
    v_exp_f32 v114, v114
    v_exp_f32 v115, v115
    v_mfma_f32_32x32x16_bf16 v[80:95], v[52:55], v[204:207], v[80:95]
    s_waitcnt lgkmcnt(0)
    v_exp_f32 v116, v116
    v_exp_f32 v117, v117
    v_exp_f32 v118, v118
    v_exp_f32 v119, v119
    v_smfmac_f32_32x32x32_bf16 v[128:143], v[28:31], v[104:111], v15
    v_exp_f32 v120, v120
    v_exp_f32 v121, v121
    v_exp_f32 v122, v122
    v_exp_f32 v123, v123
    v_smfmac_f32_32x32x32_bf16 v[144:159], v[16:19], v[112:119], v15
    v_exp_f32 v124, v124
    v_exp_f32 v125, v125
    v_exp_f32 v126, v126
    v_exp_f32 v127, v127
    v_mfma_f32_32x32x16_bf16 v[96:111], v[40:43], v[208:211], 0
    v_exp_f32 v64, v64
    v_exp_f32 v65, v65
    v_exp_f32 v66, v66
    v_exp_f32 v67, v67
    v_mfma_f32_32x32x16_bf16 v[96:111], v[44:47], v[212:215], v[96:111]
    ds_write_b128 v0, v[128:131] offset:0
    v_exp_f32 v68, v68
    v_exp_f32 v69, v69
    v_exp_f32 v70, v70
    v_exp_f32 v71, v71
    v_smfmac_f32_32x32x32_bf16 v[144:159], v[20:23], v[120:127], v15
    v_exp_f32 v72, v72
    v_exp_f32 v73, v73
    v_exp_f32 v74, v74
    v_exp_f32 v75, v75
    v_smfmac_f32_32x32x32_bf16 v[144:159], v[32:35], v[64:71], v15
    ds_write_b128 v0, v[132:135] offset:1024
    v_exp_f32 v76, v76
    v_exp_f32 v77, v77
    v_exp_f32 v78, v78
    v_exp_f32 v79, v79
    v_mfma_f32_32x32x16_bf16 v[112:127], v[56:59], v[208:211], 0
    v_exp_f32 v80, v80
    v_exp_f32 v81, v81
    v_exp_f32 v82, v82
    v_exp_f32 v83, v83
    v_mfma_f32_32x32x16_bf16 v[112:127], v[60:63], v[212:215], v[112:127]
    ds_write_b128 v0, v[136:139] offset:2048
    v_exp_f32 v84, v84
    v_exp_f32 v85, v85
    v_exp_f32 v86, v86
    v_exp_f32 v87, v87
    v_smfmac_f32_32x32x32_bf16 v[144:159], v[36:39], v[72:79], v15
    v_exp_f32 v88, v88
    v_exp_f32 v89, v89
    v_exp_f32 v90, v90
    v_exp_f32 v91, v91
    v_smfmac_f32_32x32x32_bf16 v[144:159], v[24:27], v[80:87], v15
    ds_write_b128 v0, v[140:143] offset:3072
    v_exp_f32 v92, v92
    v_exp_f32 v93, v93
    v_exp_f32 v94, v94
    v_exp_f32 v95, v95
    v_mfma_f32_32x32x16_bf16 v[64:79], v[48:51], v[208:211], 0
    v_exp_f32 v96, v96
    v_exp_f32 v97, v97
    v_exp_f32 v98, v98
    v_exp_f32 v99, v99
    v_mfma_f32_32x32x16_bf16 v[64:79], v[52:55], v[212:215], v[64:79]
    v_exp_f32 v100, v100
    v_exp_f32 v101, v101
    v_exp_f32 v102, v102
    v_exp_f32 v103, v103
    v_smfmac_f32_32x32x32_bf16 v[144:159], v[28:31], v[88:95], v15
    v_exp_f32 v104, v104
    v_exp_f32 v105, v105
    v_exp_f32 v106, v106
    v_exp_f32 v107, v107
    v_smfmac_f32_32x32x32_bf16 v[160:175], v[16:19], v[96:103], v15
    v_exp_f32 v108, v108
    v_exp_f32 v109, v109
    v_exp_f32 v110, v110
    v_exp_f32 v111, v111
    v_mfma_f32_32x32x16_bf16 v[80:95], v[40:43], v[216:219], 0
    s_setprio 2
    v_exp_f32 v112, v112
    v_exp_f32 v113, v113
    v_exp_f32 v114, v114
    v_exp_f32 v115, v115
    v_mfma_f32_32x32x16_bf16 v[80:95], v[44:47], v[220:223], v[80:95]
    ds_write_b128 v1, v[144:147] offset:0
    v_exp_f32 v116, v116
    v_exp_f32 v117, v117
    v_exp_f32 v118, v118
    v_exp_f32 v119, v119
    v_smfmac_f32_32x32x32_bf16 v[160:175], v[20:23], v[104:111], v15
    ds_write_b128 v1, v[148:151] offset:1024
    v_exp_f32 v120, v120
    v_exp_f32 v121, v121
    v_exp_f32 v122, v122
    v_exp_f32 v123, v123
    v_smfmac_f32_32x32x32_bf16 v[160:175], v[32:35], v[112:119], v15
    ds_write_b128 v1, v[152:155] offset:2048
    v_exp_f32 v124, v124
    v_exp_f32 v125, v125
    v_exp_f32 v126, v126
    v_exp_f32 v127, v127
    v_mfma_f32_32x32x16_bf16 v[96:111], v[56:59], v[216:219], 0
    ds_write_b128 v1, v[156:159] offset:3072
    v_exp_f32 v64, v64
    v_exp_f32 v65, v65
    v_exp_f32 v66, v66
    v_exp_f32 v67, v67
    v_mfma_f32_32x32x16_bf16 v[96:111], v[60:63], v[220:223], v[96:111]
    s_setprio 1
    v_exp_f32 v68, v68
    v_exp_f32 v69, v69
    v_exp_f32 v70, v70
    v_exp_f32 v71, v71
    v_smfmac_f32_32x32x32_bf16 v[160:175], v[36:39], v[120:127], v15
    s_setprio 0
    v_exp_f32 v72, v72
    v_exp_f32 v73, v73
    v_exp_f32 v74, v74
    v_exp_f32 v75, v75
    v_smfmac_f32_32x32x32_bf16 v[160:175], v[24:27], v[64:71], v15
    s_waitcnt lgkmcnt(0)
    s_barrier
    s_setprio 3
    ds_read_b128 v[128:131], v242 offset:0
    ds_read_b128 v[132:135], v242 offset:1024
    v_exp_f32 v76, v76
    v_exp_f32 v77, v77
    v_exp_f32 v78, v78
    v_exp_f32 v79, v79
    v_exp_f32 v80, v80
    v_exp_f32 v81, v81
    v_smfmac_f32_32x32x32_bf16 v[160:175], v[28:31], v[72:79], v15
    ds_read_b128 v[136:139], v242 offset:2048
    ds_read_b128 v[140:143], v242 offset:3072
    v_exp_f32 v82, v82
    v_exp_f32 v83, v83
    v_exp_f32 v84, v84
    v_mfma_f32_32x32x16_bf16 v[112:127], v[48:51], v[216:219], 0
    ds_read_b128 v[144:147], v242 offset:57344
    ds_read_b128 v[148:151], v242 offset:58368
    v_exp_f32 v85, v85
    v_exp_f32 v86, v86
    v_exp_f32 v87, v87
    v_exp_f32 v88, v88
    v_mfma_f32_32x32x16_bf16 v[112:127], v[52:55], v[220:223], v[112:127]
    ds_read_b128 v[152:155], v242 offset:59392
    ds_read_b128 v[156:159], v242 offset:60416
    v_exp_f32 v89, v89
    v_exp_f32 v90, v90
    v_exp_f32 v91, v91
    v_exp_f32 v92, v92
    v_smfmac_f32_32x32x32_bf16 v[176:191], v[16:19], v[80:87], v15
    ds_write_b128 v243, v[160:163] offset:0
    ds_write_b128 v243, v[164:167] offset:1024
    v_exp_f32 v93, v93
    v_exp_f32 v94, v94
    v_exp_f32 v95, v95
    v_exp_f32 v96, v96
    v_exp_f32 v97, v97
    v_smfmac_f32_32x32x32_bf16 v[176:191], v[20:23], v[88:95], v15
    ds_write_b128 v243, v[168:171] offset:2048
    ds_write_b128 v243, v[172:175] offset:3072
    v_exp_f32 v98, v98
    v_exp_f32 v99, v99
    v_exp_f32 v100, v100
    v_exp_f32 v101, v101
    v_exp_f32 v102, v102
    v_exp_f32 v103, v103
    v_exp_f32 v104, v104
    v_exp_f32 v105, v105
    v_smfmac_f32_32x32x32_bf16 v[176:191], v[32:35], v[96:103], v15
    s_setprio 2
    s_waitcnt lgkmcnt(4)
    v_pk_add_f32 v[128:129], v[128:129], v[144:145]
    v_pk_add_f32 v[130:131], v[130:131], v[146:147]
    v_pk_add_f32 v[132:133], v[132:133], v[148:149]
    v_pk_add_f32 v[134:135], v[134:135], v[150:151]
    v_pk_add_f32 v[136:137], v[136:137], v[152:153]
    v_pk_add_f32 v[138:139], v[138:139], v[154:155]
    v_pk_add_f32 v[140:141], v[140:141], v[156:157]
    v_pk_add_f32 v[142:143], v[142:143], v[158:159]
    s_setprio 1
    v_exp_f32 v106, v106
    v_exp_f32 v107, v107
    v_exp_f32 v108, v108
    v_exp_f32 v109, v109
    v_exp_f32 v110, v110
    v_exp_f32 v111, v111
    v_exp_f32 v112, v112
    v_exp_f32 v113, v113
    v_smfmac_f32_32x32x32_bf16 v[176:191], v[36:39], v[104:111], v15
    s_waitcnt lgkmcnt(0)
    s_barrier
    s_setprio 0
    ds_read_b128 v[160:163], v244 offset:0
    ds_read_b128 v[164:167], v244 offset:1024
    ds_read_b128 v[168:171], v244 offset:2048
    ds_read_b128 v[172:175], v244 offset:3072
    v_exp_f32 v114, v114
    v_exp_f32 v115, v115
    v_exp_f32 v116, v116
    v_exp_f32 v117, v117
    v_exp_f32 v118, v118
    v_exp_f32 v119, v119
    v_exp_f32 v120, v120
    v_exp_f32 v121, v121
    v_smfmac_f32_32x32x32_bf16 v[176:191], v[24:27], v[112:119], v15
    v_exp_f32 v122, v122
    v_exp_f32 v123, v123
    v_exp_f32 v124, v124
    v_exp_f32 v125, v125
    v_exp_f32 v126, v126
    v_exp_f32 v127, v127
    s_waitcnt lgkmcnt(0)
    s_nop 0
    v_smfmac_f32_32x32x32_bf16 v[176:191], v[28:31], v[120:127], v15
    s_setprio 1
    s_nop 0
    s_nop 1
    v_pk_add_f32 v[140:141], v[140:141], v[172:173]
    v_pk_add_f32 v[128:129], v[128:129], v[160:161]
    v_pk_add_f32 v[130:131], v[130:131], v[162:163]
    v_pk_add_f32 v[132:133], v[132:133], v[164:165]
    v_pk_add_f32 v[134:135], v[134:135], v[166:167]
    v_pk_add_f32 v[136:137], v[136:137], v[168:169]
    v_pk_add_f32 v[138:139], v[138:139], v[170:171]
    v_pk_add_f32 v[142:143], v[142:143], v[174:175]
    v_pk_add_f32 v[188:189], v[188:189], v[140:141]
    v_pk_add_f32 v[176:177], v[176:177], v[128:129]
    v_mov_b32 v226, v188
    v_mov_b32 v227, v188
    v_pk_add_f32 v[178:179], v[178:179], v[130:131]
    v_pk_add_f32 v[180:181], v[180:181], v[132:133]
    v_permlane32_swap_b32 v226, v227
    v_pk_add_f32 v[182:183], v[182:183], v[134:135]
L_final:
    v_rcp_f32 v228, v227
    v_pk_add_f32 v[184:185], v[184:185], v[136:137]
    v_pk_add_f32 v[186:187], v[186:187], v[138:139]
    v_pk_add_f32 v[190:191], v[190:191], v[142:143]
    v_pk_mul_f32 v[88:89], v[184:185], v[228:229] op_sel_hi:[1,0]
    v_pk_mul_f32 v[90:91], v[186:187], v[228:229] op_sel_hi:[1,0]
    v_pk_mul_f32 v[92:93], v[188:189], v[228:229] op_sel_hi:[1,0]
    v_pk_mul_f32 v[94:95], v[190:191], v[228:229] op_sel_hi:[1,0]
    v_cvt_pk_bf16_f32 v68, v88, v89
    v_cvt_pk_bf16_f32 v69, v90, v91
    v_cvt_pk_bf16_f32 v70, v92, v93
    v_cvt_pk_bf16_f32 v71, v94, v95
    v_pk_mul_f32 v[80:81], v[176:177], v[228:229] op_sel_hi:[1,0]
    ds_write2_b64 v14, v[68:69], v[70:71] offset0:2 offset1:3
    v_pk_mul_f32 v[82:83], v[178:179], v[228:229] op_sel_hi:[1,0]
    v_pk_mul_f32 v[84:85], v[180:181], v[228:229] op_sel_hi:[1,0]
    v_pk_mul_f32 v[86:87], v[182:183], v[228:229] op_sel_hi:[1,0]
    v_cvt_pk_bf16_f32 v64, v80, v81
    v_cvt_pk_bf16_f32 v65, v82, v83
    v_cvt_pk_bf16_f32 v66, v84, v85
    v_cvt_pk_bf16_f32 v67, v86, v87
    ds_write2_b64 v14, v[64:65], v[66:67] offset0:0 offset1:1
    ds_read_b128 v[72:75], v242 offset:0
    ds_read_b128 v[76:79], v242 offset:1024
    s_setprio 0
    s_waitcnt lgkmcnt(1)
    buffer_store_dwordx4 v[72:75], v4, s[20:23], s38 offen sc1
    s_mov_b32 exec_hi, 0xffff
    s_waitcnt lgkmcnt(0)
    buffer_store_dwordx4 v[76:79], v4, s[20:23], s38 offen offset:1024 sc1
    s_mov_b32 exec_hi, -1
    v_pk_add_f32 v[230:231], v[176:177], v[178:179]
    v_pk_add_f32 v[234:235], v[180:181], v[182:183]
    v_pk_add_f32 v[236:237], v[184:185], v[186:187]
    v_pk_add_f32 v[238:239], v[188:189], v[190:191]
    v_pk_add_f32 v[230:231], v[230:231], v[234:235]
    v_pk_add_f32 v[236:237], v[236:237], v[238:239]
    v_pk_add_f32 v[230:231], v[230:231], v[236:237]
    v_add_f32 v230, v230, v231
    v_fma_f32 v230, v230, 0, v227
    v_cmp_le_f32 vcc, 1.0, v230
    v_cmp_ge_f32 s[42:43], s44, v230
    s_nop 3
    s_and_b64 vcc, vcc, s[42:43]
    s_or_b64 vcc, vcc, s[46:47]
    s_cmp_eq_u64 vcc, -1
    s_cbranch_scc0 L_slow
L_end:
    s_endpgm
L_slow:
    s_waitcnt vmcnt(0) lgkmcnt(0)
    s_mov_b64 s[46:47], -1
    s_add_u32 s16, s6, s29
    s_addc_u32 s17, s7, 0
    s_add_u32 s24, s8, s29
    s_addc_u32 s25, s9, 0
    s_mov_b32 s26, 114688
    s_mov_b32 s27, 0x20000
    s_add_u32 s49, s48, 57344
    v_add_u32 v3, s49, v5
    s_add_u32 s41, s48, 2048
    v_add_u32 v7, s41, v240
    v_and_b32 v234, 0x13, v2
    v_cmp_eq_u32 vcc, 0x13, v234
    s_nop 1
    v_cndmask_b32 v7, v7, v240, vcc
    v_cmp_gt_u32 vcc, 32, v2
    s_nop 1
    v_cndmask_b32 v8, 0, -1, vcc
    v_mov_b32 v176, 0
    v_mov_b32 v177, 0
    v_mov_b32 v178, 0
    v_mov_b32 v179, 0
    v_mov_b32 v180, 0
    v_mov_b32 v181, 0
    v_mov_b32 v182, 0
    v_mov_b32 v183, 0
    v_mov_b32 v184, 0
    v_mov_b32 v185, 0
    v_mov_b32 v186, 0
    v_mov_b32 v187, 0
    v_mov_b32 v188, 0
    v_mov_b32 v189, 0
    v_mov_b32 v190, 0
    v_mov_b32 v191, 0
    v_mov_b32 v128, 0
    v_mov_b32 v129, 0
    v_mov_b32 v130, 0
    v_mov_b32 v131, 0
    v_mov_b32 v132, 0
    v_mov_b32 v133, 0
    v_mov_b32 v134, 0
    v_mov_b32 v135, 0
    v_mov_b32 v136, 0
    v_mov_b32 v137, 0
    v_mov_b32 v138, 0
    v_mov_b32 v139, 0
    v_mov_b32 v140, 0
    v_mov_b32 v141, 0
    v_mov_b32 v142, 0
    v_mov_b32 v143, 0
    v_mov_b32 v232, 0xff7fffff
    s_mov_b32 s30, 0
L_slow_loop:
    s_mov_b32 m0, s49
    s_nop 0
    buffer_load_dwordx4 v4, s[16:19], s30 offen offset:0 lds
    buffer_load_dwordx4 v4, s[16:19], s30 offen offset:1024 lds
    s_add_u32 m0, s49, 2048
    s_nop 0
    buffer_load_dwordx4 v4, s[24:27], s30 offen offset:0 lds
    buffer_load_dwordx4 v4, s[24:27], s30 offen offset:1024 lds
    s_waitcnt vmcnt(0)
    ds_read_b64 v[40:41], v3 offset:0
    ds_read_b64 v[42:43], v3 offset:8
    ds_read_b64 v[44:45], v3 offset:16
    ds_read_b64 v[46:47], v3 offset:24
    ds_read_b64_tr_b16 v[16:17], v7 offset:0
    ds_read_b64_tr_b16 v[18:19], v7 offset:224
    ds_read_b64_tr_b16 v[20:21], v7 offset:896
    ds_read_b64_tr_b16 v[22:23], v7 offset:1120
    s_waitcnt lgkmcnt(0)
    v_and_b32 v40, v40, v8
    v_and_b32 v41, v41, v8
    s_nop 1
    v_mfma_f32_32x32x16_bf16 v[64:79], v[40:43], v[216:219], 0
    v_mfma_f32_32x32x16_bf16 v[64:79], v[44:47], v[220:223], v[64:79]
    s_nop 11
    v_max3_f32 v236, v64, v65, v232
    v_max3_f32 v236, v66, v67, v236
    v_max3_f32 v236, v68, v69, v236
    v_max3_f32 v236, v70, v71, v236
    v_max3_f32 v236, v72, v73, v236
    v_max3_f32 v236, v74, v75, v236
    v_max3_f32 v236, v76, v77, v236
    v_max3_f32 v236, v78, v79, v236
    v_mov_b32 v237, v236
    s_nop 1
    v_permlane32_swap_b32 v236, v237
    s_nop 1
    v_max_f32 v236, v236, v237
    v_sub_f32 v237, v232, v236
    v_exp_f32 v237, v237
    v_mov_b32 v232, v236
    v_sub_f32 v64, v64, v236
    v_sub_f32 v65, v65, v236
    v_sub_f32 v66, v66, v236
    v_sub_f32 v67, v67, v236
    v_sub_f32 v68, v68, v236
    v_sub_f32 v69, v69, v236
    v_sub_f32 v70, v70, v236
    v_sub_f32 v71, v71, v236
    v_sub_f32 v72, v72, v236
    v_sub_f32 v73, v73, v236
    v_sub_f32 v74, v74, v236
    v_sub_f32 v75, v75, v236
    v_sub_f32 v76, v76, v236
    v_sub_f32 v77, v77, v236
    v_sub_f32 v78, v78, v236
    v_sub_f32 v79, v79, v236
    v_exp_f32 v64, v64
    v_exp_f32 v65, v65
    v_exp_f32 v66, v66
    v_exp_f32 v67, v67
    v_exp_f32 v68, v68
    v_exp_f32 v69, v69
    v_exp_f32 v70, v70
    v_exp_f32 v71, v71
    v_exp_f32 v72, v72
    v_exp_f32 v73, v73
    v_exp_f32 v74, v74
    v_exp_f32 v75, v75
    v_exp_f32 v76, v76
    v_exp_f32 v77, v77
    v_exp_f32 v78, v78
    v_exp_f32 v79, v79
    v_mul_f32 v176, v176, v237
    v_mul_f32 v177, v177, v237
    v_mul_f32 v178, v178, v237
    v_mul_f32 v179, v179, v237
    v_mul_f32 v180, v180, v237
    v_mul_f32 v181, v181, v237
    v_mul_f32 v182, v182, v237
    v_mul_f32 v183, v183, v237
    v_mul_f32 v184, v184, v237
    v_mul_f32 v185, v185, v237
    v_mul_f32 v186, v186, v237
    v_mul_f32 v187, v187, v237
    v_mul_f32 v188, v188, v237
    v_mul_f32 v189, v189, v237
    v_mul_f32 v190, v190, v237
    v_mul_f32 v191, v191, v237
    s_nop 1
    v_smfmac_f32_32x32x32_bf16 v[176:191], v[16:19], v[64:71], v15
    v_smfmac_f32_32x32x32_bf16 v[176:191], v[20:23], v[72:79], v15
    s_nop 11
    s_add_u32 s30, s30, 1792
    s_cmp_lt_u32 s30, 114688
    s_cbranch_scc1 L_slow_loop
    v_mov_b32 v226, v188
    v_mov_b32 v227, v188
    s_nop 1
    v_permlane32_swap_b32 v226, v227
    s_nop 1
    s_branch L_final
.section .rodata,"a"
.p2align 6
.amdhsa_kernel standalone__fused_io_aware_attn__prompt_kernel
  .amdhsa_next_free_vgpr 248
  .amdhsa_next_free_sgpr 96
  .amdhsa_accum_offset 248
  .amdhsa_group_segment_fixed_size 0
  .amdhsa_kernarg_size 48
  .amdhsa_user_sgpr_count 2
  .amdhsa_user_sgpr_kernarg_segment_ptr 1
  .amdhsa_system_sgpr_workgroup_id_x 1
.end_amdhsa_kernel
```
